```python
import torch

def _softmax(x, axis=-1):
    return torch.softmax(x, dim=axis)
def _gelu(x):
    return torch.nn.functional.gelu(x, approximate="tanh")
def _silu(x):
    return torch.nn.functional.silu(x)
def _sigmoid(x):
    return torch.sigmoid(x)
def _layernorm(x, axis=-1, eps=1e-5):
    m = x.mean(dim=axis, keepdim=True)
    v = x.var(dim=axis, keepdim=True, unbiased=False)
    return (x - m) / torch.sqrt(v + eps)
def _scatter_add(tgt, idx, src, axis=0):
    return tgt.clone().index_add_(axis, idx, src)
def _segment_sum(src, seg, n):
    out = torch.zeros((n,) + src.shape[1:], dtype=src.dtype)
    return out.index_add_(0, seg, src)
def _pad(x, pw):
    flat = tuple(v for pair in reversed(pw) for v in pair)
    return torch.nn.functional.pad(x, flat)

kernel_name = 'gated_mix__ssm_conv_s4__glu_gated_swiglu__prompt'

def setup_inputs():

    _w = (lambda a: (lambda t: t.to(torch.bfloat16) if t.is_floating_point() else t)(torch.as_tensor(a)))
    def _A_setup():
        B, L, D, N = 1, 2048, 512, 128
        A_re = -(lambda _x: torch.exp(torch.as_tensor(_x)))((lambda *s: torch.randn(*s, dtype=torch.bfloat16) * 3.2)(D, N))
        A_im = torch.pi * (lambda *s: torch.randn(*s, dtype=torch.bfloat16) * 0.05)(D, N)
        B_re = (lambda *s: torch.randn(*s, dtype=torch.bfloat16) * 0.1)(D, N)
        B_im = (lambda *s: torch.randn(*s, dtype=torch.bfloat16) * 0.1)(D, N)
        C_re = (lambda *s: torch.randn(*s, dtype=torch.bfloat16) * 0.1)(D, N)
        C_im = (lambda *s: torch.randn(*s, dtype=torch.bfloat16) * 0.1)(D, N)
        log_dt = (lambda *s: torch.randn(*s, dtype=torch.bfloat16) * 0.05)(D) * 0.5 - 4.0
        Dskip = (lambda *s: torch.randn(*s, dtype=torch.bfloat16) * 0.05)(D)
        return {
            "u": _w((lambda *s: torch.randn(*s, dtype=torch.bfloat16) * 0.05)(B, L, D)),
            "A_re": _w(A_re),
            "A_im": _w(A_im),
            "B_re": _w(B_re),
            "B_im": _w(B_im),
            "C_re": _w(C_re),
            "C_im": _w(C_im),
            "log_dt": _w(log_dt),
            "Dskip": _w(Dskip),
        }
    _A_in = _A_setup()

    def _B_setup():
        B, S, D, F = 1, 2048, 512, 1792
        return {
            "x": _w((lambda *s: torch.randn(*s, dtype=torch.bfloat16) * 0.05)(B, S, D)),
            "w1": _w((lambda *s: torch.randn(*s, dtype=torch.bfloat16) * 0.8)(D, F) * (2.0 / D) ** 0.5),
            "w3": _w((lambda *s: torch.randn(*s, dtype=torch.bfloat16) * 0.8)(D, F) * (2.0 / D) ** 0.5),
            "w2": _w((lambda *s: torch.randn(*s, dtype=torch.bfloat16) * 0.8)(F, D) * (2.0 / F) ** 0.5),
        }
    _B_in = _B_setup()

    return {
        "A_u": _A_in["u"],
        "A_A_re": _A_in["A_re"],
        "A_A_im": _A_in["A_im"],
        "A_B_re": _A_in["B_re"],
        "A_B_im": _A_in["B_im"],
        "A_C_re": _A_in["C_re"],
        "A_C_im": _A_in["C_im"],
        "A_log_dt": _A_in["log_dt"],
        "A_Dskip": _A_in["Dskip"],
        "B_x": _B_in["x"],
        "B_w1": _B_in["w1"],
        "B_w3": _B_in["w3"],
        "B_w2": _B_in["w2"],
        "gate_w": _w((lambda *s: torch.randn(*s, dtype=torch.bfloat16) * 0.05)(512) * 16.0),
    }

def reference(A_u, A_A_re, A_A_im, A_B_re, A_B_im, A_C_re, A_C_im, A_log_dt, A_Dskip, B_x, B_w1, B_w3, B_w2, gate_w):
    def _A_ref(u, A_re, A_im, B_re, B_im, C_re, C_im, log_dt, Dskip):
        Bsz, L, D = u.shape
        dt = torch.exp(log_dt)[:, None]
        A = A_re + 1j * A_im
        Bc = B_re + 1j * B_im
        Cc = C_re + 1j * C_im
        logdA = dt * A
        dB = dt * Bc
        l = (lambda x, dt: x.to(dt))(torch.arange(L), A_re.dtype)
        P = torch.exp(logdA[:, :, None] * l[None, None, :])
        K = torch.einsum("dn,dnl,dn->dl", Cc, P, dB).real
        L2 = 2 * L
        Kp = _pad(K, ((0, 0), (0, L)))
        up = (lambda x, *d: x.permute(*d))(u, 0, 2, 1)
        up = _pad(up, ((0, 0), (0, 0), (0, L)))
        Kf = (lambda x, axes=(-2,-1): torch.fft.rfft2(x.float(), dim=axes))(Kp[:, None, :], axes=(-2, -1))
        Uf = (lambda x, axes=(-2,-1): torch.fft.rfft2(x.float(), dim=axes))(up[:, :, None, :], axes=(-2, -1))
        Yf = Uf * Kf[None, :, :, :]
        y = (lambda x, s, axes=(-2,-1): torch.fft.irfft2(x, s=s, dim=axes).to(torch.bfloat16))(Yf, (1, L2), axes=(-2, -1))[:, :, 0, :L]
        y = (lambda x, *d: x.permute(*d))(y, 0, 2, 1) + u * Dskip[None, None, :]
        return y

    def _B_ref(x, w1, w3, w2):
        gate = torch.einsum("bsd,df->bsf", x, w1)
        up = torch.einsum("bsd,df->bsf", x, w3)
        h = _silu(gate) * up
        out = torch.einsum("bsf,fd->bsd", h, w2)
        return out

    x = A_u
    g = _sigmoid((x * gate_w).sum(-1, keepdims=True))
    a = _A_ref(x, A_A_re, A_A_im, A_B_re, A_B_im, A_C_re, A_C_im, A_log_dt, A_Dskip)
    b = _B_ref(x, B_w1, B_w3, B_w2)
    return g * a + (1 - g) * b
```

```asm
; @launch grid=(256,1,1) block=(512,1,1) lds=163840
.amdgcn_target "amdgcn-amd-amdhsa--gfx950"
.text
.globl gated_mix__ssm_conv_s4__glu_gated_swiglu__prompt_kernel
.p2align 8
.type gated_mix__ssm_conv_s4__glu_gated_swiglu__prompt_kernel,@function
gated_mix__ssm_conv_s4__glu_gated_swiglu__prompt_kernel:
    s_load_dwordx16 s[36:51], s[0:1], 0
    s_load_dwordx16 s[52:67], s[0:1], 64
    s_load_dwordx2 s[68:69], s[0:1], 128
    s_cmp_ge_u32 s2, 256
    s_cbranch_scc1 L_end
    s_getpc_b64 s[6:7]
L_pc0:
    v_lshlrev_b32 v1, 6, v0
    v_min_u32 v1, L_codeend-L_pc0, v1
    global_load_dword v31, v1, s[6:7]
L_nocpf:
    v_lshrrev_b32 v2, 6, v0
    v_and_b32 v1, 63, v0
    v_readfirstlane_b32 s3, v2
    s_and_b32 s6, s2, 7
    s_lshr_b32 s7, s2, 3
    s_and_b32 s4, s6, 1
    s_lshl_b32 s4, s4, 2
    s_and_b32 s30, s7, 3
    s_add_u32 s4, s4, s30
    s_lshr_b32 s5, s6, 1
    s_mul_i32 s5, s5, 7
    s_lshr_b32 s30, s7, 2
    s_add_u32 s5, s5, s30
    s_cmp_lt_u32 s3, 4
    s_cbranch_scc1 L_w03
    s_cmp_ge_u32 s3, 6
    s_cbranch_scc1 L_kfin
    s_cmp_lg_u32 s3, 4
    s_cbranch_scc1 L_noinit
    v_mov_b32 v3, 0
    v_mov_b32 v4, 155136
    v_lshl_add_u32 v4, v1, 2, v4
    ds_write_b32 v4, v3
L_noinit:
    v_lshrrev_b32 v2, 3, v1
    v_and_b32 v3, 7, v1
    v_lshrrev_b32 v4, 4, v1
    v_xor_b32 v5, v3, v4
    v_xor_b32 v6, 4, v5
    v_lshlrev_b32 v7, 10, v2
    v_lshl_add_u32 v8, v5, 4, v7
    v_lshl_add_u32 v9, v6, 4, v7
    v_add_u32 v10, 14336, v8
    v_add_u32 v11, 21504, v9
    v_add_u32 v9, 7168, v9
    v_and_b32 v4, 1, v4
    v_lshlrev_b32 v4, 1, v4
    v_xor_b32 v5, v3, v4
    v_mul_u32_u24 v7, 3584, v2
    v_lshl_add_u32 v12, v5, 4, v7
    v_xor_b32 v5, 4, v5
    v_lshl_add_u32 v13, v5, 4, v7
    v_add_u32 v14, 55296, v12
    v_add_u32 v15, 82944, v13
    v_add_u32 v13, 27648, v13
    s_waitcnt lgkmcnt(0)
    s_mov_b32 s0, 0x100000
    s_mov_b32 s8, s36
    s_and_b32 s9, s37, 0xffff
    s_mov_b32 s10, 2097152
    s_mov_b32 s11, 0x00020000
    s_mov_b32 s12, s56
    s_and_b32 s13, s57, 0xffff
    s_mov_b32 s14, 1835008
    s_mov_b32 s15, 0x00020000
    s_mov_b32 s20, s68
    s_and_b32 s21, s69, 0xffff
    s_mov_b32 s22, 20971520
    s_mov_b32 s23, 0x00020000
    s_mov_b32 s16, s60
    s_and_b32 s17, s61, 0xffff
    s_mov_b32 s18, 1835008
    s_mov_b32 s19, 0x00020000
    s_mov_b32 s24, s64
    s_and_b32 s25, s65, 0xffff
    s_mov_b32 s26, 2097152
    s_mov_b32 s27, 0x00020000
    s_barrier
    s_cmp_ge_u32 s2, 224
    s_cbranch_scc1 L_spare45
    s_sub_u32 s6, s3, 4
    s_cmp_eq_u32 s6, 1
    s_cselect_b32 s12, s58, s56
    s_cselect_b32 s13, s59, s57
    s_and_b32 s13, s13, 0xffff
    s_lshl_b32 s28, s4, 18
    s_lshl_b32 s7, s6, 17
    s_add_u32 s28, s28, s7
    s_lshl_b32 s29, s5, 7
    s_lshl_b32 s34, s6, 14
    s_add_u32 s34, s34, 49152
    s_lshl_b32 s35, s6, 13
    s_add_u32 s35, s35, 81920
    s_add_u32 s33, s29, 114688
    s_add_u32 m0, s35, 0
    s_nop 0
    buffer_load_dwordx4 v12, s[12:15], s29 offen offset:0 lds
    buffer_load_dwordx4 v13, s[12:15], s29 offen offset:1024 lds
    buffer_load_dwordx4 v14, s[12:15], s29 offen offset:2048 lds
    buffer_load_dwordx4 v15, s[12:15], s29 offen offset:3072 lds
    s_add_u32 m0, s35, 4096
    s_nop 0
    buffer_load_dwordx4 v12, s[12:15], s33 offen offset:0 lds
    buffer_load_dwordx4 v13, s[12:15], s33 offen offset:1024 lds
    buffer_load_dwordx4 v14, s[12:15], s33 offen offset:2048 lds
    buffer_load_dwordx4 v15, s[12:15], s33 offen offset:3072 lds
    s_mov_b32 s33, s28
    s_add_u32 m0, s34, 0
    s_nop 0
    buffer_load_dwordx4 v8, s[8:11], s33 offen offset:0 lds
    buffer_load_dwordx4 v9, s[8:11], s33 offen offset:1024 lds
    buffer_load_dwordx4 v10, s[8:11], s33 offen offset:2048 lds
    buffer_load_dwordx4 v11, s[8:11], s33 offen offset:3072 lds
    s_add_u32 s33, s33, 32768
    s_add_u32 m0, s34, 4096
    s_nop 0
    buffer_load_dwordx4 v8, s[8:11], s33 offen offset:0 lds
    buffer_load_dwordx4 v9, s[8:11], s33 offen offset:1024 lds
    buffer_load_dwordx4 v10, s[8:11], s33 offen offset:2048 lds
    buffer_load_dwordx4 v11, s[8:11], s33 offen offset:3072 lds
    s_add_u32 s33, s33, 32768
    s_add_u32 m0, s34, 8192
    s_nop 0
    buffer_load_dwordx4 v8, s[8:11], s33 offen offset:0 lds
    buffer_load_dwordx4 v9, s[8:11], s33 offen offset:1024 lds
    buffer_load_dwordx4 v10, s[8:11], s33 offen offset:2048 lds
    buffer_load_dwordx4 v11, s[8:11], s33 offen offset:3072 lds
    s_add_u32 s33, s33, 32768
    s_add_u32 m0, s34, 12288
    s_nop 0
    buffer_load_dwordx4 v8, s[8:11], s33 offen offset:0 lds
    buffer_load_dwordx4 v9, s[8:11], s33 offen offset:1024 lds
    buffer_load_dwordx4 v10, s[8:11], s33 offen offset:2048 lds
    buffer_load_dwordx4 v11, s[8:11], s33 offen offset:3072 lds
    s_add_u32 s28, s28, 128
    s_add_u32 s29, s29, 229376
    s_add_u32 s33, s29, 114688
    s_add_u32 m0, s35, 49152
    s_nop 0
    buffer_load_dwordx4 v12, s[12:15], s29 offen offset:0 lds
    buffer_load_dwordx4 v13, s[12:15], s29 offen offset:1024 lds
    buffer_load_dwordx4 v14, s[12:15], s29 offen offset:2048 lds
    buffer_load_dwordx4 v15, s[12:15], s29 offen offset:3072 lds
    s_add_u32 m0, s35, 53248
    s_nop 0
    buffer_load_dwordx4 v12, s[12:15], s33 offen offset:0 lds
    buffer_load_dwordx4 v13, s[12:15], s33 offen offset:1024 lds
    buffer_load_dwordx4 v14, s[12:15], s33 offen offset:2048 lds
    buffer_load_dwordx4 v15, s[12:15], s33 offen offset:3072 lds
    s_mov_b32 s33, s28
    s_add_u32 m0, s34, 49152
    s_nop 0
    buffer_load_dwordx4 v8, s[8:11], s33 offen offset:0 lds
    buffer_load_dwordx4 v9, s[8:11], s33 offen offset:1024 lds
    buffer_load_dwordx4 v10, s[8:11], s33 offen offset:2048 lds
    buffer_load_dwordx4 v11, s[8:11], s33 offen offset:3072 lds
    s_add_u32 s33, s33, 32768
    s_add_u32 m0, s34, 53248
    s_nop 0
    buffer_load_dwordx4 v8, s[8:11], s33 offen offset:0 lds
    buffer_load_dwordx4 v9, s[8:11], s33 offen offset:1024 lds
    buffer_load_dwordx4 v10, s[8:11], s33 offen offset:2048 lds
    buffer_load_dwordx4 v11, s[8:11], s33 offen offset:3072 lds
    s_add_u32 s33, s33, 32768
    s_add_u32 m0, s34, 57344
    s_nop 0
    buffer_load_dwordx4 v8, s[8:11], s33 offen offset:0 lds
    buffer_load_dwordx4 v9, s[8:11], s33 offen offset:1024 lds
    buffer_load_dwordx4 v10, s[8:11], s33 offen offset:2048 lds
    buffer_load_dwordx4 v11, s[8:11], s33 offen offset:3072 lds
    s_add_u32 s33, s33, 32768
    s_add_u32 m0, s34, 61440
    s_nop 0
    buffer_load_dwordx4 v8, s[8:11], s33 offen offset:0 lds
    buffer_load_dwordx4 v9, s[8:11], s33 offen offset:1024 lds
    buffer_load_dwordx4 v10, s[8:11], s33 offen offset:2048 lds
    buffer_load_dwordx4 v11, s[8:11], s33 offen offset:3072 lds
    s_waitcnt vmcnt(24)
    s_barrier
    s_add_u32 s28, s28, 128
    s_add_u32 s29, s29, 229376
    s_add_u32 s33, s29, 114688
    s_add_u32 m0, s35, 4294918144
    s_nop 0
    buffer_load_dwordx4 v12, s[12:15], s29 offen offset:0 lds
    buffer_load_dwordx4 v13, s[12:15], s29 offen offset:1024 lds
    buffer_load_dwordx4 v14, s[12:15], s29 offen offset:2048 lds
    buffer_load_dwordx4 v15, s[12:15], s29 offen offset:3072 lds
    s_add_u32 m0, s35, 4294922240
    s_nop 0
    buffer_load_dwordx4 v12, s[12:15], s33 offen offset:0 lds
    buffer_load_dwordx4 v13, s[12:15], s33 offen offset:1024 lds
    buffer_load_dwordx4 v14, s[12:15], s33 offen offset:2048 lds
    buffer_load_dwordx4 v15, s[12:15], s33 offen offset:3072 lds
    s_mov_b32 s33, s28
    s_add_u32 m0, s34, 4294918144
    s_nop 0
    buffer_load_dwordx4 v8, s[8:11], s33 offen offset:0 lds
    buffer_load_dwordx4 v9, s[8:11], s33 offen offset:1024 lds
    buffer_load_dwordx4 v10, s[8:11], s33 offen offset:2048 lds
    buffer_load_dwordx4 v11, s[8:11], s33 offen offset:3072 lds
    s_waitcnt vmcnt(12)
    s_barrier
    s_add_u32 s33, s33, 32768
    s_add_u32 m0, s34, 4294922240
    s_nop 0
    buffer_load_dwordx4 v8, s[8:11], s33 offen offset:0 lds
    buffer_load_dwordx4 v9, s[8:11], s33 offen offset:1024 lds
    buffer_load_dwordx4 v10, s[8:11], s33 offen offset:2048 lds
    buffer_load_dwordx4 v11, s[8:11], s33 offen offset:3072 lds
    s_add_u32 s33, s33, 32768
    s_add_u32 m0, s34, 4294926336
    s_nop 0
    buffer_load_dwordx4 v8, s[8:11], s33 offen offset:0 lds
    buffer_load_dwordx4 v9, s[8:11], s33 offen offset:1024 lds
    buffer_load_dwordx4 v10, s[8:11], s33 offen offset:2048 lds
    buffer_load_dwordx4 v11, s[8:11], s33 offen offset:3072 lds
    s_add_u32 s33, s33, 32768
    s_add_u32 m0, s34, 4294930432
    s_nop 0
    buffer_load_dwordx4 v8, s[8:11], s33 offen offset:0 lds
    buffer_load_dwordx4 v9, s[8:11], s33 offen offset:1024 lds
    buffer_load_dwordx4 v10, s[8:11], s33 offen offset:2048 lds
    buffer_load_dwordx4 v11, s[8:11], s33 offen offset:3072 lds
    s_add_u32 s28, s28, 128
    s_add_u32 s29, s29, 229376
    s_add_u32 s33, s29, 114688
    s_add_u32 m0, s35, 0
    s_nop 0
    buffer_load_dwordx4 v12, s[12:15], s29 offen offset:0 lds
    buffer_load_dwordx4 v13, s[12:15], s29 offen offset:1024 lds
    buffer_load_dwordx4 v14, s[12:15], s29 offen offset:2048 lds
    buffer_load_dwordx4 v15, s[12:15], s29 offen offset:3072 lds
    s_add_u32 m0, s35, 4096
    s_nop 0
    buffer_load_dwordx4 v12, s[12:15], s33 offen offset:0 lds
    buffer_load_dwordx4 v13, s[12:15], s33 offen offset:1024 lds
    buffer_load_dwordx4 v14, s[12:15], s33 offen offset:2048 lds
    buffer_load_dwordx4 v15, s[12:15], s33 offen offset:3072 lds
    s_mov_b32 s33, s28
    s_add_u32 m0, s34, 0
    s_nop 0
    buffer_load_dwordx4 v8, s[8:11], s33 offen offset:0 lds
    buffer_load_dwordx4 v9, s[8:11], s33 offen offset:1024 lds
    buffer_load_dwordx4 v10, s[8:11], s33 offen offset:2048 lds
    buffer_load_dwordx4 v11, s[8:11], s33 offen offset:3072 lds
    s_add_u32 s33, s33, 32768
    s_add_u32 m0, s34, 4096
    s_nop 0
    buffer_load_dwordx4 v8, s[8:11], s33 offen offset:0 lds
    buffer_load_dwordx4 v9, s[8:11], s33 offen offset:1024 lds
    buffer_load_dwordx4 v10, s[8:11], s33 offen offset:2048 lds
    s_waitcnt vmcnt(15)
    s_barrier
    buffer_load_dwordx4 v11, s[8:11], s33 offen offset:3072 lds
    s_add_u32 s33, s33, 32768
    s_add_u32 m0, s34, 8192
    s_nop 0
    buffer_load_dwordx4 v8, s[8:11], s33 offen offset:0 lds
    buffer_load_dwordx4 v9, s[8:11], s33 offen offset:1024 lds
    buffer_load_dwordx4 v10, s[8:11], s33 offen offset:2048 lds
    buffer_load_dwordx4 v11, s[8:11], s33 offen offset:3072 lds
    s_add_u32 s33, s33, 32768
    s_add_u32 m0, s34, 12288
    s_nop 0
    buffer_load_dwordx4 v8, s[8:11], s33 offen offset:0 lds
    buffer_load_dwordx4 v9, s[8:11], s33 offen offset:1024 lds
    buffer_load_dwordx4 v10, s[8:11], s33 offen offset:2048 lds
    buffer_load_dwordx4 v11, s[8:11], s33 offen offset:3072 lds
    s_add_u32 s28, s28, 128
    s_add_u32 s29, s29, 229376
    s_add_u32 s33, s29, 114688
    s_add_u32 m0, s35, 49152
    s_nop 0
    buffer_load_dwordx4 v12, s[12:15], s29 offen offset:0 lds
    buffer_load_dwordx4 v13, s[12:15], s29 offen offset:1024 lds
    buffer_load_dwordx4 v14, s[12:15], s29 offen offset:2048 lds
    buffer_load_dwordx4 v15, s[12:15], s29 offen offset:3072 lds
    s_add_u32 m0, s35, 53248
    s_nop 0
    buffer_load_dwordx4 v12, s[12:15], s33 offen offset:0 lds
    buffer_load_dwordx4 v13, s[12:15], s33 offen offset:1024 lds
    buffer_load_dwordx4 v14, s[12:15], s33 offen offset:2048 lds
    buffer_load_dwordx4 v15, s[12:15], s33 offen offset:3072 lds
    s_mov_b32 s33, s28
    s_add_u32 m0, s34, 49152
    s_nop 0
    buffer_load_dwordx4 v8, s[8:11], s33 offen offset:0 lds
    buffer_load_dwordx4 v9, s[8:11], s33 offen offset:1024 lds
    buffer_load_dwordx4 v10, s[8:11], s33 offen offset:2048 lds
    buffer_load_dwordx4 v11, s[8:11], s33 offen offset:3072 lds
    s_add_u32 s33, s33, 32768
    s_add_u32 m0, s34, 53248
    s_nop 0
    buffer_load_dwordx4 v8, s[8:11], s33 offen offset:0 lds
    buffer_load_dwordx4 v9, s[8:11], s33 offen offset:1024 lds
    buffer_load_dwordx4 v10, s[8:11], s33 offen offset:2048 lds
    buffer_load_dwordx4 v11, s[8:11], s33 offen offset:3072 lds
    s_add_u32 s33, s33, 32768
    s_add_u32 m0, s34, 57344
    s_nop 0
    buffer_load_dwordx4 v8, s[8:11], s33 offen offset:0 lds
    buffer_load_dwordx4 v9, s[8:11], s33 offen offset:1024 lds
    s_waitcnt vmcnt(18)
    s_barrier
    buffer_load_dwordx4 v10, s[8:11], s33 offen offset:2048 lds
    buffer_load_dwordx4 v11, s[8:11], s33 offen offset:3072 lds
    s_add_u32 s33, s33, 32768
    s_add_u32 m0, s34, 61440
    s_nop 0
    buffer_load_dwordx4 v8, s[8:11], s33 offen offset:0 lds
    buffer_load_dwordx4 v9, s[8:11], s33 offen offset:1024 lds
    buffer_load_dwordx4 v10, s[8:11], s33 offen offset:2048 lds
    buffer_load_dwordx4 v11, s[8:11], s33 offen offset:3072 lds
    s_add_u32 s28, s28, 128
    s_add_u32 s29, s29, 229376
    s_add_u32 s33, s29, 114688
    s_add_u32 m0, s35, 4294918144
    s_nop 0
    buffer_load_dwordx4 v12, s[12:15], s29 offen offset:0 lds
    buffer_load_dwordx4 v13, s[12:15], s29 offen offset:1024 lds
    buffer_load_dwordx4 v14, s[12:15], s29 offen offset:2048 lds
    buffer_load_dwordx4 v15, s[12:15], s29 offen offset:3072 lds
    s_add_u32 m0, s35, 4294922240
    s_nop 0
    buffer_load_dwordx4 v12, s[12:15], s33 offen offset:0 lds
    buffer_load_dwordx4 v13, s[12:15], s33 offen offset:1024 lds
    buffer_load_dwordx4 v14, s[12:15], s33 offen offset:2048 lds
    buffer_load_dwordx4 v15, s[12:15], s33 offen offset:3072 lds
    s_mov_b32 s33, s28
    s_add_u32 m0, s34, 4294918144
    s_nop 0
    buffer_load_dwordx4 v8, s[8:11], s33 offen offset:0 lds
    buffer_load_dwordx4 v9, s[8:11], s33 offen offset:1024 lds
    buffer_load_dwordx4 v10, s[8:11], s33 offen offset:2048 lds
    buffer_load_dwordx4 v11, s[8:11], s33 offen offset:3072 lds
    s_add_u32 s33, s33, 32768
    s_add_u32 m0, s34, 4294922240
    s_nop 0
    buffer_load_dwordx4 v8, s[8:11], s33 offen offset:0 lds
    buffer_load_dwordx4 v9, s[8:11], s33 offen offset:1024 lds
    buffer_load_dwordx4 v10, s[8:11], s33 offen offset:2048 lds
    buffer_load_dwordx4 v11, s[8:11], s33 offen offset:3072 lds
    s_add_u32 s33, s33, 32768
    s_add_u32 m0, s34, 4294926336
    s_nop 0
    buffer_load_dwordx4 v8, s[8:11], s33 offen offset:0 lds
    buffer_load_dwordx4 v9, s[8:11], s33 offen offset:1024 lds
    buffer_load_dwordx4 v10, s[8:11], s33 offen offset:2048 lds
    buffer_load_dwordx4 v11, s[8:11], s33 offen offset:3072 lds
    s_add_u32 s33, s33, 32768
    s_add_u32 m0, s34, 4294930432
    s_nop 0
    buffer_load_dwordx4 v8, s[8:11], s33 offen offset:0 lds
    s_waitcnt vmcnt(21)
    s_barrier
    buffer_load_dwordx4 v9, s[8:11], s33 offen offset:1024 lds
    buffer_load_dwordx4 v10, s[8:11], s33 offen offset:2048 lds
    buffer_load_dwordx4 v11, s[8:11], s33 offen offset:3072 lds
    s_add_u32 s28, s28, 128
    s_add_u32 s29, s29, 229376
    s_add_u32 s33, s29, 114688
    s_add_u32 m0, s35, 0
    s_nop 0
    buffer_load_dwordx4 v12, s[12:15], s29 offen offset:0 lds
    buffer_load_dwordx4 v13, s[12:15], s29 offen offset:1024 lds
    buffer_load_dwordx4 v14, s[12:15], s29 offen offset:2048 lds
    buffer_load_dwordx4 v15, s[12:15], s29 offen offset:3072 lds
    s_add_u32 m0, s35, 4096
    s_nop 0
    buffer_load_dwordx4 v12, s[12:15], s33 offen offset:0 lds
    buffer_load_dwordx4 v13, s[12:15], s33 offen offset:1024 lds
    buffer_load_dwordx4 v14, s[12:15], s33 offen offset:2048 lds
    buffer_load_dwordx4 v15, s[12:15], s33 offen offset:3072 lds
    s_mov_b32 s33, s28
    s_add_u32 m0, s34, 0
    s_nop 0
    buffer_load_dwordx4 v8, s[8:11], s33 offen offset:0 lds
    buffer_load_dwordx4 v9, s[8:11], s33 offen offset:1024 lds
    buffer_load_dwordx4 v10, s[8:11], s33 offen offset:2048 lds
    buffer_load_dwordx4 v11, s[8:11], s33 offen offset:3072 lds
    s_add_u32 s33, s33, 32768
    s_add_u32 m0, s34, 4096
    s_nop 0
    buffer_load_dwordx4 v8, s[8:11], s33 offen offset:0 lds
    buffer_load_dwordx4 v9, s[8:11], s33 offen offset:1024 lds
    buffer_load_dwordx4 v10, s[8:11], s33 offen offset:2048 lds
    buffer_load_dwordx4 v11, s[8:11], s33 offen offset:3072 lds
    s_add_u32 s33, s33, 32768
    s_add_u32 m0, s34, 8192
    s_nop 0
    buffer_load_dwordx4 v8, s[8:11], s33 offen offset:0 lds
    buffer_load_dwordx4 v9, s[8:11], s33 offen offset:1024 lds
    buffer_load_dwordx4 v10, s[8:11], s33 offen offset:2048 lds
    buffer_load_dwordx4 v11, s[8:11], s33 offen offset:3072 lds
    s_add_u32 s33, s33, 32768
    s_add_u32 m0, s34, 12288
    s_nop 0
    buffer_load_dwordx4 v8, s[8:11], s33 offen offset:0 lds
    buffer_load_dwordx4 v9, s[8:11], s33 offen offset:1024 lds
    buffer_load_dwordx4 v10, s[8:11], s33 offen offset:2048 lds
    buffer_load_dwordx4 v11, s[8:11], s33 offen offset:3072 lds
    s_waitcnt vmcnt(24)
    s_barrier
    s_add_u32 s28, s28, 128
    s_add_u32 s29, s29, 229376
    s_add_u32 s33, s29, 114688
    s_add_u32 m0, s35, 49152
    s_nop 0
    buffer_load_dwordx4 v12, s[12:15], s29 offen offset:0 lds
    buffer_load_dwordx4 v13, s[12:15], s29 offen offset:1024 lds
    buffer_load_dwordx4 v14, s[12:15], s29 offen offset:2048 lds
    buffer_load_dwordx4 v15, s[12:15], s29 offen offset:3072 lds
    s_add_u32 m0, s35, 53248
    s_nop 0
    buffer_load_dwordx4 v12, s[12:15], s33 offen offset:0 lds
    buffer_load_dwordx4 v13, s[12:15], s33 offen offset:1024 lds
    buffer_load_dwordx4 v14, s[12:15], s33 offen offset:2048 lds
    buffer_load_dwordx4 v15, s[12:15], s33 offen offset:3072 lds
    s_mov_b32 s33, s28
    s_add_u32 m0, s34, 49152
    s_nop 0
    buffer_load_dwordx4 v8, s[8:11], s33 offen offset:0 lds
    buffer_load_dwordx4 v9, s[8:11], s33 offen offset:1024 lds
    buffer_load_dwordx4 v10, s[8:11], s33 offen offset:2048 lds
    buffer_load_dwordx4 v11, s[8:11], s33 offen offset:3072 lds
    s_add_u32 s33, s33, 32768
    s_add_u32 m0, s34, 53248
    s_nop 0
    buffer_load_dwordx4 v8, s[8:11], s33 offen offset:0 lds
    buffer_load_dwordx4 v9, s[8:11], s33 offen offset:1024 lds
    buffer_load_dwordx4 v10, s[8:11], s33 offen offset:2048 lds
    buffer_load_dwordx4 v11, s[8:11], s33 offen offset:3072 lds
    s_add_u32 s33, s33, 32768
    s_add_u32 m0, s34, 57344
    s_nop 0
    buffer_load_dwordx4 v8, s[8:11], s33 offen offset:0 lds
    buffer_load_dwordx4 v9, s[8:11], s33 offen offset:1024 lds
    buffer_load_dwordx4 v10, s[8:11], s33 offen offset:2048 lds
    buffer_load_dwordx4 v11, s[8:11], s33 offen offset:3072 lds
    s_add_u32 s33, s33, 32768
    s_add_u32 m0, s34, 61440
    s_nop 0
    buffer_load_dwordx4 v8, s[8:11], s33 offen offset:0 lds
    buffer_load_dwordx4 v9, s[8:11], s33 offen offset:1024 lds
    buffer_load_dwordx4 v10, s[8:11], s33 offen offset:2048 lds
    buffer_load_dwordx4 v11, s[8:11], s33 offen offset:3072 lds
    s_waitcnt vmcnt(24)
    s_barrier
    s_add_u32 s28, s28, 128
    s_add_u32 s29, s29, 229376
L_ph2_loader:
    s_lshl_b32 s7, s2, 1
    s_add_u32 s7, s7, s6
    s_lshl_b32 s28, s7, 1
    v_mov_b32 v3, s28
    global_load_ushort v20, v3, s[52:53]
    v_lshrrev_b32 v2, 3, v1
    v_and_b32 v3, 7, v1
    v_bfe_u32 v4, v1, 4, 2
    v_lshlrev_b32 v4, 1, v4
    v_xor_b32 v3, v3, v4
    v_lshlrev_b32 v2, 10, v2
    v_lshl_add_u32 v8, v3, 4, v2
    v_add_u32 v9, 7168, v8
    v_add_u32 v10, 14336, v8
    v_add_u32 v11, 21504, v8
    s_lshr_b32 s5, s2, 5
    s_mul_i32 s24, s6, 458752
    s_lshl_b32 s25, s5, 7
    s_add_u32 s24, s24, s25
    s_lshl_b32 s26, s6, 12
    s_add_u32 s26, s26, 0
    s_lshl_b32 s28, s6, 2
    s_add_u32 s28, s28, 155176
    v_mov_b32 v21, s28
    s_add_u32 m0, s26, 0
    s_add_u32 s28, s24, 0
    buffer_load_dwordx4 v8, s[16:19], s28 offen offset:0 lds
    buffer_load_dwordx4 v9, s[16:19], s28 offen offset:1024 lds
    buffer_load_dwordx4 v10, s[16:19], s28 offen offset:2048 lds
    buffer_load_dwordx4 v11, s[16:19], s28 offen offset:3072 lds
    s_add_u32 m0, s26, 8192
    s_add_u32 s28, s24, 917504
    buffer_load_dwordx4 v8, s[16:19], s28 offen offset:0 lds
    buffer_load_dwordx4 v9, s[16:19], s28 offen offset:1024 lds
    buffer_load_dwordx4 v10, s[16:19], s28 offen offset:2048 lds
    buffer_load_dwordx4 v11, s[16:19], s28 offen offset:3072 lds
    s_add_u32 m0, s26, 16384
    s_add_u32 s28, s24, 65536
    buffer_load_dwordx4 v8, s[16:19], s28 offen offset:0 lds
    buffer_load_dwordx4 v9, s[16:19], s28 offen offset:1024 lds
    buffer_load_dwordx4 v10, s[16:19], s28 offen offset:2048 lds
    buffer_load_dwordx4 v11, s[16:19], s28 offen offset:3072 lds
    s_add_u32 m0, s26, 24576
    s_add_u32 s28, s24, 983040
    buffer_load_dwordx4 v8, s[16:19], s28 offen offset:0 lds
    buffer_load_dwordx4 v9, s[16:19], s28 offen offset:1024 lds
    buffer_load_dwordx4 v10, s[16:19], s28 offen offset:2048 lds
    buffer_load_dwordx4 v11, s[16:19], s28 offen offset:3072 lds
    s_add_u32 m0, s26, 32768
    s_add_u32 s28, s24, 131072
    buffer_load_dwordx4 v8, s[16:19], s28 offen offset:0 lds
    buffer_load_dwordx4 v9, s[16:19], s28 offen offset:1024 lds
    buffer_load_dwordx4 v10, s[16:19], s28 offen offset:2048 lds
    buffer_load_dwordx4 v11, s[16:19], s28 offen offset:3072 lds
    s_add_u32 m0, s26, 40960
    s_add_u32 s28, s24, 1048576
    buffer_load_dwordx4 v8, s[16:19], s28 offen offset:0 lds
    buffer_load_dwordx4 v9, s[16:19], s28 offen offset:1024 lds
    buffer_load_dwordx4 v10, s[16:19], s28 offen offset:2048 lds
    buffer_load_dwordx4 v11, s[16:19], s28 offen offset:3072 lds
    s_waitcnt vmcnt(24)
    s_cmp_ge_u32 s2, 224
    s_cbranch_scc1 L_bar1
    s_barrier
L_bar1:
    s_add_u32 m0, s26, 49152
    s_add_u32 s28, s24, 196608
    buffer_load_dwordx4 v8, s[16:19], s28 offen offset:0 lds
    buffer_load_dwordx4 v9, s[16:19], s28 offen offset:1024 lds
    buffer_load_dwordx4 v10, s[16:19], s28 offen offset:2048 lds
    buffer_load_dwordx4 v11, s[16:19], s28 offen offset:3072 lds
    s_add_u32 m0, s26, 57344
    s_add_u32 s28, s24, 1114112
    buffer_load_dwordx4 v8, s[16:19], s28 offen offset:0 lds
    buffer_load_dwordx4 v9, s[16:19], s28 offen offset:1024 lds
    buffer_load_dwordx4 v10, s[16:19], s28 offen offset:2048 lds
    buffer_load_dwordx4 v11, s[16:19], s28 offen offset:3072 lds
    s_add_u32 m0, s26, 65536
    s_add_u32 s28, s24, 262144
    buffer_load_dwordx4 v8, s[16:19], s28 offen offset:0 lds
    buffer_load_dwordx4 v9, s[16:19], s28 offen offset:1024 lds
    buffer_load_dwordx4 v10, s[16:19], s28 offen offset:2048 lds
    buffer_load_dwordx4 v11, s[16:19], s28 offen offset:3072 lds
    s_add_u32 m0, s26, 73728
    s_add_u32 s28, s24, 1179648
    buffer_load_dwordx4 v8, s[16:19], s28 offen offset:0 lds
    buffer_load_dwordx4 v9, s[16:19], s28 offen offset:1024 lds
    buffer_load_dwordx4 v10, s[16:19], s28 offen offset:2048 lds
    buffer_load_dwordx4 v11, s[16:19], s28 offen offset:3072 lds
    s_add_u32 m0, s26, 81920
    s_add_u32 s28, s24, 327680
    buffer_load_dwordx4 v8, s[16:19], s28 offen offset:0 lds
    buffer_load_dwordx4 v9, s[16:19], s28 offen offset:1024 lds
    buffer_load_dwordx4 v10, s[16:19], s28 offen offset:2048 lds
    buffer_load_dwordx4 v11, s[16:19], s28 offen offset:3072 lds
    s_add_u32 m0, s26, 90112
    s_add_u32 s28, s24, 1245184
    buffer_load_dwordx4 v8, s[16:19], s28 offen offset:0 lds
    buffer_load_dwordx4 v9, s[16:19], s28 offen offset:1024 lds
    buffer_load_dwordx4 v10, s[16:19], s28 offen offset:2048 lds
    buffer_load_dwordx4 v11, s[16:19], s28 offen offset:3072 lds
    s_waitcnt vmcnt(24)
    s_cmp_ge_u32 s2, 224
    s_cbranch_scc1 L_bar2
    s_barrier
L_bar2:
    s_add_u32 m0, s26, 98304
    s_add_u32 s28, s24, 393216
    buffer_load_dwordx4 v8, s[16:19], s28 offen offset:0 lds
    buffer_load_dwordx4 v9, s[16:19], s28 offen offset:1024 lds
    buffer_load_dwordx4 v10, s[16:19], s28 offen offset:2048 lds
    buffer_load_dwordx4 v11, s[16:19], s28 offen offset:3072 lds
    s_add_u32 m0, s26, 106496
    s_add_u32 s28, s24, 1310720
    buffer_load_dwordx4 v8, s[16:19], s28 offen offset:0 lds
    buffer_load_dwordx4 v9, s[16:19], s28 offen offset:1024 lds
    buffer_load_dwordx4 v10, s[16:19], s28 offen offset:2048 lds
    buffer_load_dwordx4 v11, s[16:19], s28 offen offset:3072 lds
    v_mov_b32 v22, 1
    s_waitcnt vmcnt(0)
    ds_write_b32 v21, v22
    s_lshl_b32 s28, s6, 2
    s_add_u32 s28, s28, 155168
    s_lshl_b32 s30, s6, 13
    s_add_u32 s30, s30, 147456
    v_mov_b32 v17, s28
L_lw_w2eo:
    s_sub_u32 s0, s0, 1
    s_cbranch_scc1 L_end
    s_sleep 2
    ds_read_b32 v24, v17
    s_waitcnt lgkmcnt(0)
    v_cmp_gt_u32 vcc, 1, v24
    s_cbranch_vccnz L_lw_w2eo
    s_mov_b32 s33, 1
    s_branch L_conv
L_w03:
    s_lshr_b32 s6, s3, 1
    s_lshl_b32 s7, s2, 1
    s_add_u32 s7, s7, s6
    s_lshl_b32 s28, s7, 8
    s_and_b32 s29, s3, 1
    s_lshl_b32 s29, s29, 7
    s_add_u32 s28, s28, s29
    v_lshl_add_u32 v2, v1, 1, s28
    s_lshl_b32 s29, s7, 1
    v_mov_b32 v3, s29
    v_lshrrev_b32 v21, 3, v1
    v_mul_u32_u24 v21, 229376, v21
    v_and_b32 v22, 7, v1
    v_lshl_add_u32 v21, v22, 7, v21
    s_lshr_b32 s32, s3, 1
    s_mul_i32 s32, s32, 3
    s_add_u32 s32, s32, 2
    s_mul_i32 s32, s32, 229376
    s_lshl_b32 s33, s2, 10
    s_add_u32 s32, s32, s33
    s_waitcnt lgkmcnt(0)
    global_load_short_d16_hi v64, v2, s[38:39]
    global_load_short_d16_hi v65, v2, s[40:41]
    global_load_short_d16_hi v66, v2, s[42:43]
    global_load_short_d16_hi v67, v2, s[44:45]
    global_load_short_d16_hi v68, v2, s[46:47]
    global_load_short_d16_hi v69, v2, s[48:49]
    global_load_short_d16_hi v70, v3, s[50:51]
    s_barrier
    s_mov_b32 s0, 0x100000
    s_mov_b32 s8, s36
    s_and_b32 s9, s37, 0xffff
    s_mov_b32 s10, 2097152
    s_mov_b32 s11, 0x00020000
    s_mov_b32 s12, s56
    s_and_b32 s13, s57, 0xffff
    s_mov_b32 s14, 1835008
    s_mov_b32 s15, 0x00020000
    s_mov_b32 s20, s68
    s_and_b32 s21, s69, 0xffff
    s_mov_b32 s22, 20971520
    s_mov_b32 s23, 0x00020000
    s_mov_b32 s16, s60
    s_and_b32 s17, s61, 0xffff
    s_mov_b32 s18, 1835008
    s_mov_b32 s19, 0x00020000
    s_mov_b32 s24, s64
    s_and_b32 s25, s65, 0xffff
    s_mov_b32 s26, 2097152
    s_mov_b32 s27, 0x00020000
    s_cmp_ge_u32 s2, 224
    s_cbranch_scc1 L_kt
    v_and_b32 v2, 15, v1
    v_lshrrev_b32 v3, 4, v1
    v_bfe_u32 v4, v2, 1, 3
    s_lshl_b32 s28, s3, 13
    s_add_u32 s28, s28, 49152
    v_lshlrev_b32 v5, 7, v2
    v_add_u32 v5, s28, v5
    v_add_u32 v6, 0, v3
    v_xor_b32 v6, v6, v4
    v_lshl_add_u32 v8, v6, 4, v5
    v_add_u32 v6, 4, v3
    v_xor_b32 v6, v6, v4
    v_lshl_add_u32 v9, v6, 4, v5
    v_bfe_u32 v2, v1, 2, 2
    v_and_b32 v3, 3, v1
    v_lshrrev_b32 v4, 4, v1
    v_lshl_add_u32 v6, v4, 3, v2
    v_lshlrev_b32 v6, 7, v6
    v_lshl_add_u32 v6, v3, 3, v6
    v_add_u32 v6, 81920, v6
    v_lshrrev_b32 v7, 1, v2
    v_and_b32 v4, 1, v4
    v_lshl_or_b32 v7, v4, 1, v7
    v_xor_b32 v5, 0, v7
    v_lshl_add_u32 v12, v5, 5, v6
    v_xor_b32 v5, 1, v7
    v_lshl_add_u32 v13, v5, 5, v6
    v_xor_b32 v5, 2, v7
    v_lshl_add_u32 v14, v5, 5, v6
    v_xor_b32 v5, 3, v7
    v_lshl_add_u32 v15, v5, 5, v6
    v_pk_mul_f32 v[128:129], 0, 0
    v_pk_mul_f32 v[130:131], 0, 0
    v_pk_mul_f32 v[132:133], 0, 0
    v_pk_mul_f32 v[134:135], 0, 0
    v_pk_mul_f32 v[136:137], 0, 0
    v_pk_mul_f32 v[138:139], 0, 0
    v_pk_mul_f32 v[140:141], 0, 0
    v_pk_mul_f32 v[142:143], 0, 0
    v_pk_mul_f32 v[144:145], 0, 0
    v_pk_mul_f32 v[146:147], 0, 0
    v_pk_mul_f32 v[148:149], 0, 0
    v_pk_mul_f32 v[150:151], 0, 0
    v_pk_mul_f32 v[152:153], 0, 0
    v_pk_mul_f32 v[154:155], 0, 0
    v_pk_mul_f32 v[156:157], 0, 0
    v_pk_mul_f32 v[158:159], 0, 0
    v_pk_mul_f32 v[160:161], 0, 0
    v_pk_mul_f32 v[162:163], 0, 0
    v_pk_mul_f32 v[164:165], 0, 0
    v_pk_mul_f32 v[166:167], 0, 0
    v_pk_mul_f32 v[168:169], 0, 0
    v_pk_mul_f32 v[170:171], 0, 0
    v_pk_mul_f32 v[172:173], 0, 0
    v_pk_mul_f32 v[174:175], 0, 0
    v_pk_mul_f32 v[176:177], 0, 0
    v_pk_mul_f32 v[178:179], 0, 0
    v_pk_mul_f32 v[180:181], 0, 0
    v_pk_mul_f32 v[182:183], 0, 0
    v_pk_mul_f32 v[184:185], 0, 0
    v_pk_mul_f32 v[186:187], 0, 0
    v_pk_mul_f32 v[188:189], 0, 0
    v_pk_mul_f32 v[190:191], 0, 0
    v_pk_mul_f32 v[192:193], 0, 0
    v_pk_mul_f32 v[194:195], 0, 0
    v_pk_mul_f32 v[196:197], 0, 0
    v_pk_mul_f32 v[198:199], 0, 0
    v_pk_mul_f32 v[200:201], 0, 0
    v_pk_mul_f32 v[202:203], 0, 0
    v_pk_mul_f32 v[204:205], 0, 0
    v_pk_mul_f32 v[206:207], 0, 0
    v_pk_mul_f32 v[208:209], 0, 0
    v_pk_mul_f32 v[210:211], 0, 0
    v_pk_mul_f32 v[212:213], 0, 0
    v_pk_mul_f32 v[214:215], 0, 0
    v_pk_mul_f32 v[216:217], 0, 0
    v_pk_mul_f32 v[218:219], 0, 0
    v_pk_mul_f32 v[220:221], 0, 0
    v_pk_mul_f32 v[222:223], 0, 0
    v_pk_mul_f32 v[224:225], 0, 0
    v_pk_mul_f32 v[226:227], 0, 0
    v_pk_mul_f32 v[228:229], 0, 0
    v_pk_mul_f32 v[230:231], 0, 0
    v_pk_mul_f32 v[232:233], 0, 0
    v_pk_mul_f32 v[234:235], 0, 0
    v_pk_mul_f32 v[236:237], 0, 0
    v_pk_mul_f32 v[238:239], 0, 0
    v_pk_mul_f32 v[240:241], 0, 0
    v_pk_mul_f32 v[242:243], 0, 0
    v_pk_mul_f32 v[244:245], 0, 0
    v_pk_mul_f32 v[246:247], 0, 0
    v_pk_mul_f32 v[248:249], 0, 0
    v_pk_mul_f32 v[250:251], 0, 0
    v_pk_mul_f32 v[252:253], 0, 0
    v_pk_mul_f32 v[254:255], 0, 0
    s_lshl_b32 s28, s3, 2
    s_add_u32 s28, s28, 155152
    v_mov_b32 v19, s28
    v_mov_b32 v20, 0
    s_bitcmp1_b32 s3, 0
    s_cselect_b32 s12, s58, s56
    s_cselect_b32 s13, s59, s57
    s_and_b32 s13, s13, 0xffff
    s_mov_b64 exec, 0xffffff
    buffer_load_dword v23, v21, s[12:15], s32 offen
    s_mov_b64 exec, -1
L_kt:
    s_mul_i32 s30, s3, 4352
    s_add_u32 s30, s30, 0
    v_lshl_add_u32 v21, v1, 4, s30
    v_bfe_u32 v6, v1, 2, 2
    v_lshrrev_b32 v7, 4, v1
    v_lshl_add_u32 v6, v7, 3, v6
    v_lshl_add_u32 v22, v6, 4, s30
    v_and_b32 v6, 1, v1
    v_lshl_add_u32 v22, v6, 3, v22
    v_bfe_u32 v6, v1, 1, 1
    v_mul_u32_u24 v6, 1088, v6
    v_add_u32 v22, v6, v22
    s_mov_b32 s31, 0xffff0000
    s_mov_b32 s32, 1069066811
    s_mov_b32 s33, 849703008
    s_mov_b32 s34, 1042479491
    s_cmp_lt_u32 s2, 224
    s_cbranch_scc1 L_kt_w1
    s_waitcnt vmcnt(0)
L_kt_w1:
    s_waitcnt vmcnt(1)
    v_and_b32 v64, s31, v64
    v_and_b32 v65, s31, v65
    v_and_b32 v66, s31, v66
    v_and_b32 v67, s31, v67
    v_and_b32 v68, s31, v68
    v_and_b32 v69, s31, v69
    v_and_b32 v70, s31, v70
    v_mul_f32 v72, s32, v70
    v_fma_f32 v73, v70, s32, -v72
    v_fmac_f32 v73, s33, v70
    v_exp_f32 v72, v72
    v_mul_f32 v73, 1060205080, v73
    v_fmac_f32 v72, v72, v73
    v_cvt_pk_bf16_f32 v72, v72, v72
    v_and_b32 v72, s31, v72
    v_mul_f32 v74, v72, v64
    v_mul_f32 v75, v72, v65
    v_mul_f32 v66, v72, v66
    v_mul_f32 v67, v72, v67
    v_mul_f32 v74, s32, v74
    v_mul_f32 v75, s34, v75
    v_pk_mul_f32 v[32:33], v[68:69], v[66:67] op_sel:[0,0] op_sel_hi:[0,1]
    v_pk_fma_f32 v[32:33], v[68:69], v[66:67], v[32:33] op_sel:[1,1,0] op_sel_hi:[1,0,1] neg_lo:[0,1,0]
    v_mul_f32 v82, 1090519040, v74
    v_mul_f32 v83, 1090519040, v75
    v_mul_f32 v86, 1.0, v74
    v_mul_f32 v87, 1.0, v75
    v_mul_f32 v90, 1124073472, v74
    v_mul_f32 v91, 1124073472, v75
    v_exp_f32 v82, v82
    v_fract_f32 v83, v83
    v_exp_f32 v86, v86
    v_fract_f32 v87, v87
    v_exp_f32 v90, v90
    v_fract_f32 v91, v91
    v_cos_f32 v84, v83
    v_sin_f32 v85, v83
    v_cos_f32 v88, v87
    v_sin_f32 v89, v87
    v_cos_f32 v92, v91
    v_sin_f32 v93, v91
    v_mov_b32 v24, 1.0
    v_mul_f32 v26, v82, v84
    v_mul_f32 v27, -v82, v85
    v_mul_f32 v76, v86, v88
    v_mul_f32 v77, v86, v89
    v_mul_f32 v58, v90, v92
    v_mul_f32 v59, v90, v93
    v_mov_b32 v25, 0
    v_pk_mul_f32 v[28:29], v[26:27], v[26:27] op_sel:[0,0] op_sel_hi:[0,1]
    v_pk_mul_f32 v[56:57], v[76:77], v[76:77] op_sel:[0,0] op_sel_hi:[0,1]
    v_pk_mul_f32 v[34:35], v[32:33], v[76:77] op_sel:[0,0] op_sel_hi:[0,1]
    v_pk_mul_f32 v[36:37], v[32:33], v[58:59] op_sel:[0,0] op_sel_hi:[0,1]
    v_pk_mul_f32 v[60:61], v[58:59], v[58:59] op_sel:[0,0] op_sel_hi:[0,1]
    v_pk_fma_f32 v[28:29], v[26:27], v[26:27], v[28:29] op_sel:[1,1,0] op_sel_hi:[1,0,1] neg_lo:[0,1,0]
    v_pk_fma_f32 v[56:57], v[76:77], v[76:77], v[56:57] op_sel:[1,1,0] op_sel_hi:[1,0,1] neg_lo:[0,1,0]
    v_pk_fma_f32 v[34:35], v[32:33], v[76:77], v[34:35] op_sel:[1,1,0] op_sel_hi:[1,0,1] neg_lo:[0,1,0]
    v_pk_fma_f32 v[36:37], v[32:33], v[58:59], v[36:37] op_sel:[1,1,0] op_sel_hi:[1,0,1] neg_lo:[0,1,0]
    v_pk_fma_f32 v[60:61], v[58:59], v[58:59], v[60:61] op_sel:[1,1,0] op_sel_hi:[1,0,1] neg_lo:[0,1,0]
    v_pk_mul_f32 v[30:31], v[28:29], v[26:27] op_sel:[0,0] op_sel_hi:[0,1]
    v_pk_mul_f32 v[62:63], v[28:29], v[28:29] op_sel:[0,0] op_sel_hi:[0,1]
    v_pk_mul_f32 v[38:39], v[36:37], v[76:77] op_sel:[0,0] op_sel_hi:[0,1]
    v_pk_mul_f32 v[78:79], v[56:57], v[56:57] op_sel:[0,0] op_sel_hi:[0,1]
    v_pk_mul_f32 v[40:41], v[32:33], v[60:61] op_sel:[0,0] op_sel_hi:[0,1]
    v_pk_mul_f32 v[42:43], v[36:37], v[60:61] op_sel:[0,0] op_sel_hi:[0,1]
    v_pk_mul_f32 v[80:81], v[60:61], v[60:61] op_sel:[0,0] op_sel_hi:[0,1]
    v_pk_fma_f32 v[30:31], v[28:29], v[26:27], v[30:31] op_sel:[1,1,0] op_sel_hi:[1,0,1] neg_lo:[0,1,0]
    v_pk_fma_f32 v[62:63], v[28:29], v[28:29], v[62:63] op_sel:[1,1,0] op_sel_hi:[1,0,1] neg_lo:[0,1,0]
    v_pk_fma_f32 v[38:39], v[36:37], v[76:77], v[38:39] op_sel:[1,1,0] op_sel_hi:[1,0,1] neg_lo:[0,1,0]
    v_pk_fma_f32 v[78:79], v[56:57], v[56:57], v[78:79] op_sel:[1,1,0] op_sel_hi:[1,0,1] neg_lo:[0,1,0]
    v_pk_fma_f32 v[40:41], v[32:33], v[60:61], v[40:41] op_sel:[1,1,0] op_sel_hi:[1,0,1] neg_lo:[0,1,0]
    v_pk_fma_f32 v[42:43], v[36:37], v[60:61], v[42:43] op_sel:[1,1,0] op_sel_hi:[1,0,1] neg_lo:[0,1,0]
    v_pk_fma_f32 v[80:81], v[60:61], v[60:61], v[80:81] op_sel:[1,1,0] op_sel_hi:[1,0,1] neg_lo:[0,1,0]
    v_pk_mul_f32 v[44:45], v[40:41], v[60:61] op_sel:[0,0] op_sel_hi:[0,1]
    v_pk_mul_f32 v[82:83], v[80:81], v[80:81] op_sel:[0,0] op_sel_hi:[0,1]
    v_pk_fma_f32 v[44:45], v[40:41], v[60:61], v[44:45] op_sel:[1,1,0] op_sel_hi:[1,0,1] neg_lo:[0,1,0]
    v_pk_fma_f32 v[82:83], v[80:81], v[80:81], v[82:83] op_sel:[1,1,0] op_sel_hi:[1,0,1] neg_lo:[0,1,0]
    v_pk_mul_f32 v[46:47], v[44:45], v[78:79] op_sel:[0,0] op_sel_hi:[0,1]
    v_pk_mul_f32 v[50:51], v[82:83], v[36:37] op_sel:[0,0] op_sel_hi:[0,1]
    v_pk_mul_f32 v[48:49], v[82:83], v[32:33] op_sel:[0,0] op_sel_hi:[0,1]
    v_pk_fma_f32 v[46:47], v[44:45], v[78:79], v[46:47] op_sel:[1,1,0] op_sel_hi:[1,0,1] neg_lo:[0,1,0]
    v_pk_fma_f32 v[50:51], v[82:83], v[36:37], v[50:51] op_sel:[1,1,0] op_sel_hi:[1,0,1] neg_lo:[0,1,0]
    v_pk_fma_f32 v[48:49], v[82:83], v[32:33], v[48:49] op_sel:[1,1,0] op_sel_hi:[1,0,1] neg_lo:[0,1,0]
    v_pk_mul_f32 v[102:103], v[26:27], v[62:63] op_sel:[0,0] op_sel_hi:[0,1]
    v_pk_mul_f32 v[108:109], v[28:29], v[62:63] op_sel:[0,0] op_sel_hi:[0,1]
    v_pk_mul_f32 v[114:115], v[30:31], v[62:63] op_sel:[0,0] op_sel_hi:[0,1]
    v_pk_fma_f32 v[102:103], v[26:27], v[62:63], v[102:103] op_sel:[1,1,0] op_sel_hi:[1,0,1] neg_lo:[0,1,0]
    v_pk_fma_f32 v[108:109], v[28:29], v[62:63], v[108:109] op_sel:[1,1,0] op_sel_hi:[1,0,1] neg_lo:[0,1,0]
    v_pk_fma_f32 v[114:115], v[30:31], v[62:63], v[114:115] op_sel:[1,1,0] op_sel_hi:[1,0,1] neg_lo:[0,1,0]
    v_pk_mul_f32 v[98:99], v[62:63], v[62:63] op_sel:[0,0] op_sel_hi:[0,1]
    v_pk_mul_f32 v[104:105], v[102:103], v[62:63] op_sel:[0,0] op_sel_hi:[0,1]
    v_pk_mul_f32 v[110:111], v[108:109], v[62:63] op_sel:[0,0] op_sel_hi:[0,1]
    v_pk_mul_f32 v[116:117], v[114:115], v[62:63] op_sel:[0,0] op_sel_hi:[0,1]
    v_pk_fma_f32 v[98:99], v[62:63], v[62:63], v[98:99] op_sel:[1,1,0] op_sel_hi:[1,0,1] neg_lo:[0,1,0]
    v_pk_fma_f32 v[104:105], v[102:103], v[62:63], v[104:105] op_sel:[1,1,0] op_sel_hi:[1,0,1] neg_lo:[0,1,0]
    v_pk_fma_f32 v[110:111], v[108:109], v[62:63], v[110:111] op_sel:[1,1,0] op_sel_hi:[1,0,1] neg_lo:[0,1,0]
    v_pk_fma_f32 v[116:117], v[114:115], v[62:63], v[116:117] op_sel:[1,1,0] op_sel_hi:[1,0,1] neg_lo:[0,1,0]
    v_pk_mul_f32 v[100:101], v[98:99], v[62:63] op_sel:[0,0] op_sel_hi:[0,1]
    v_pk_mul_f32 v[106:107], v[104:105], v[62:63] op_sel:[0,0] op_sel_hi:[0,1]
    v_pk_mul_f32 v[112:113], v[110:111], v[62:63] op_sel:[0,0] op_sel_hi:[0,1]
    v_pk_mul_f32 v[118:119], v[116:117], v[62:63] op_sel:[0,0] op_sel_hi:[0,1]
    v_pk_fma_f32 v[100:101], v[98:99], v[62:63], v[100:101] op_sel:[1,1,0] op_sel_hi:[1,0,1] neg_lo:[0,1,0]
    v_pk_fma_f32 v[106:107], v[104:105], v[62:63], v[106:107] op_sel:[1,1,0] op_sel_hi:[1,0,1] neg_lo:[0,1,0]
    v_pk_fma_f32 v[112:113], v[110:111], v[62:63], v[112:113] op_sel:[1,1,0] op_sel_hi:[1,0,1] neg_lo:[0,1,0]
    v_pk_fma_f32 v[118:119], v[116:117], v[62:63], v[118:119] op_sel:[1,1,0] op_sel_hi:[1,0,1] neg_lo:[0,1,0]
    v_cvt_pk_bf16_f32 v120, v24, v62
    v_cvt_pk_bf16_f32 v121, v98, v100
    v_cvt_pk_bf16_f32 v122, v26, v102
    v_cvt_pk_bf16_f32 v123, v104, v106
    ds_write_b128 v21, v[120:123] offset:0
    v_cvt_pk_bf16_f32 v124, v25, v63
    v_cvt_pk_bf16_f32 v125, v99, v101
    v_cvt_pk_bf16_f32 v126, v27, v103
    v_cvt_pk_bf16_f32 v127, v105, v107
    ds_write_b128 v21, v[124:127] offset:2176
    v_cvt_pk_bf16_f32 v120, v28, v108
    v_cvt_pk_bf16_f32 v121, v110, v112
    v_cvt_pk_bf16_f32 v122, v30, v114
    v_cvt_pk_bf16_f32 v123, v116, v118
    ds_write_b128 v21, v[120:123] offset:1088
    v_cvt_pk_bf16_f32 v124, v29, v109
    v_cvt_pk_bf16_f32 v125, v111, v113
    v_cvt_pk_bf16_f32 v126, v31, v115
    v_cvt_pk_bf16_f32 v127, v117, v119
    ds_write_b128 v21, v[124:127] offset:3264
    ds_read_b64_tr_b16 v[64:65], v22 offset:0
    ds_read_b64_tr_b16 v[66:67], v22 offset:64
    ds_read_b64_tr_b16 v[68:69], v22 offset:512
    ds_read_b64_tr_b16 v[70:71], v22 offset:576
    ds_read_b64_tr_b16 v[72:73], v22 offset:2176
    ds_read_b64_tr_b16 v[74:75], v22 offset:2240
    ds_read_b64_tr_b16 v[76:77], v22 offset:2688
    ds_read_b64_tr_b16 v[78:79], v22 offset:2752
    v_pk_mul_f32 v[96:97], v[32:33], v[56:57] op_sel:[0,0] op_sel_hi:[0,1]
    v_pk_mul_f32 v[102:103], v[34:35], v[56:57] op_sel:[0,0] op_sel_hi:[0,1]
    v_pk_mul_f32 v[108:109], v[36:37], v[56:57] op_sel:[0,0] op_sel_hi:[0,1]
    v_pk_mul_f32 v[114:115], v[38:39], v[56:57] op_sel:[0,0] op_sel_hi:[0,1]
    v_pk_fma_f32 v[96:97], v[32:33], v[56:57], v[96:97] op_sel:[1,1,0] op_sel_hi:[1,0,1] neg_lo:[0,1,0]
    v_pk_fma_f32 v[102:103], v[34:35], v[56:57], v[102:103] op_sel:[1,1,0] op_sel_hi:[1,0,1] neg_lo:[0,1,0]
    v_pk_fma_f32 v[108:109], v[36:37], v[56:57], v[108:109] op_sel:[1,1,0] op_sel_hi:[1,0,1] neg_lo:[0,1,0]
    v_pk_fma_f32 v[114:115], v[38:39], v[56:57], v[114:115] op_sel:[1,1,0] op_sel_hi:[1,0,1] neg_lo:[0,1,0]
    v_pk_mul_f32 v[98:99], v[96:97], v[56:57] op_sel:[0,0] op_sel_hi:[0,1]
    v_pk_mul_f32 v[104:105], v[102:103], v[56:57] op_sel:[0,0] op_sel_hi:[0,1]
    v_pk_mul_f32 v[110:111], v[108:109], v[56:57] op_sel:[0,0] op_sel_hi:[0,1]
    v_pk_mul_f32 v[116:117], v[114:115], v[56:57] op_sel:[0,0] op_sel_hi:[0,1]
    v_pk_fma_f32 v[98:99], v[96:97], v[56:57], v[98:99] op_sel:[1,1,0] op_sel_hi:[1,0,1] neg_lo:[0,1,0]
    v_pk_fma_f32 v[104:105], v[102:103], v[56:57], v[104:105] op_sel:[1,1,0] op_sel_hi:[1,0,1] neg_lo:[0,1,0]
    v_pk_fma_f32 v[110:111], v[108:109], v[56:57], v[110:111] op_sel:[1,1,0] op_sel_hi:[1,0,1] neg_lo:[0,1,0]
    v_pk_fma_f32 v[116:117], v[114:115], v[56:57], v[116:117] op_sel:[1,1,0] op_sel_hi:[1,0,1] neg_lo:[0,1,0]
    v_pk_mul_f32 v[100:101], v[98:99], v[56:57] op_sel:[0,0] op_sel_hi:[0,1]
    v_pk_mul_f32 v[106:107], v[104:105], v[56:57] op_sel:[0,0] op_sel_hi:[0,1]
    v_pk_mul_f32 v[112:113], v[110:111], v[56:57] op_sel:[0,0] op_sel_hi:[0,1]
    v_pk_mul_f32 v[118:119], v[116:117], v[56:57] op_sel:[0,0] op_sel_hi:[0,1]
    v_pk_fma_f32 v[100:101], v[98:99], v[56:57], v[100:101] op_sel:[1,1,0] op_sel_hi:[1,0,1] neg_lo:[0,1,0]
    v_pk_fma_f32 v[106:107], v[104:105], v[56:57], v[106:107] op_sel:[1,1,0] op_sel_hi:[1,0,1] neg_lo:[0,1,0]
    v_pk_fma_f32 v[112:113], v[110:111], v[56:57], v[112:113] op_sel:[1,1,0] op_sel_hi:[1,0,1] neg_lo:[0,1,0]
    v_pk_fma_f32 v[118:119], v[116:117], v[56:57], v[118:119] op_sel:[1,1,0] op_sel_hi:[1,0,1] neg_lo:[0,1,0]
    v_cvt_pk_bf16_f32 v120, v32, v96
    v_cvt_pk_bf16_f32 v121, v98, v100
    v_cvt_pk_bf16_f32 v122, v34, v102
    v_cvt_pk_bf16_f32 v123, v104, v106
    ds_write_b128 v21, v[120:123] offset:0
    v_cvt_pk_bf16_f32 v124, v33, v97
    v_cvt_pk_bf16_f32 v125, v99, v101
    v_cvt_pk_bf16_f32 v126, v35, v103
    v_cvt_pk_bf16_f32 v127, v105, v107
    ds_write_b128 v21, v[124:127] offset:2176
    v_cvt_pk_bf16_f32 v120, v36, v108
    v_cvt_pk_bf16_f32 v121, v110, v112
    v_cvt_pk_bf16_f32 v122, v38, v114
    v_cvt_pk_bf16_f32 v123, v116, v118
    ds_write_b128 v21, v[120:123] offset:1088
    v_cvt_pk_bf16_f32 v124, v37, v109
    v_cvt_pk_bf16_f32 v125, v111, v113
    v_cvt_pk_bf16_f32 v126, v39, v115
    v_cvt_pk_bf16_f32 v127, v117, v119
    ds_write_b128 v21, v[124:127] offset:3264
    ds_read_b64_tr_b16 v[80:81], v22 offset:0
    ds_read_b64_tr_b16 v[82:83], v22 offset:64
    ds_read_b64_tr_b16 v[84:85], v22 offset:512
    ds_read_b64_tr_b16 v[86:87], v22 offset:576
    ds_read_b64_tr_b16 v[88:89], v22 offset:2176
    ds_read_b64_tr_b16 v[90:91], v22 offset:2240
    ds_read_b64_tr_b16 v[92:93], v22 offset:2688
    ds_read_b64_tr_b16 v[94:95], v22 offset:2752
    v_pk_mul_f32 v[96:97], v[40:41], v[56:57] op_sel:[0,0] op_sel_hi:[0,1]
    v_pk_mul_f32 v[102:103], v[42:43], v[56:57] op_sel:[0,0] op_sel_hi:[0,1]
    v_pk_mul_f32 v[108:109], v[44:45], v[58:59] op_sel:[0,0] op_sel_hi:[0,1]
    v_pk_mul_f32 v[114:115], v[46:47], v[58:59] op_sel:[0,0] op_sel_hi:[0,1]
    v_pk_fma_f32 v[96:97], v[40:41], v[56:57], v[96:97] op_sel:[1,1,0] op_sel_hi:[1,0,1] neg_lo:[0,1,0]
    v_pk_fma_f32 v[102:103], v[42:43], v[56:57], v[102:103] op_sel:[1,1,0] op_sel_hi:[1,0,1] neg_lo:[0,1,0]
    v_pk_fma_f32 v[108:109], v[44:45], v[58:59], v[108:109] op_sel:[1,1,0] op_sel_hi:[1,0,1] neg_lo:[0,1,0]
    v_pk_fma_f32 v[114:115], v[46:47], v[58:59], v[114:115] op_sel:[1,1,0] op_sel_hi:[1,0,1] neg_lo:[0,1,0]
    v_pk_mul_f32 v[98:99], v[96:97], v[56:57] op_sel:[0,0] op_sel_hi:[0,1]
    v_pk_mul_f32 v[104:105], v[102:103], v[56:57] op_sel:[0,0] op_sel_hi:[0,1]
    v_pk_mul_f32 v[110:111], v[108:109], v[58:59] op_sel:[0,0] op_sel_hi:[0,1]
    v_pk_mul_f32 v[116:117], v[114:115], v[58:59] op_sel:[0,0] op_sel_hi:[0,1]
    v_pk_fma_f32 v[98:99], v[96:97], v[56:57], v[98:99] op_sel:[1,1,0] op_sel_hi:[1,0,1] neg_lo:[0,1,0]
    v_pk_fma_f32 v[104:105], v[102:103], v[56:57], v[104:105] op_sel:[1,1,0] op_sel_hi:[1,0,1] neg_lo:[0,1,0]
    v_pk_fma_f32 v[110:111], v[108:109], v[58:59], v[110:111] op_sel:[1,1,0] op_sel_hi:[1,0,1] neg_lo:[0,1,0]
    v_pk_fma_f32 v[116:117], v[114:115], v[58:59], v[116:117] op_sel:[1,1,0] op_sel_hi:[1,0,1] neg_lo:[0,1,0]
    v_pk_mul_f32 v[100:101], v[98:99], v[56:57] op_sel:[0,0] op_sel_hi:[0,1]
    v_pk_mul_f32 v[106:107], v[104:105], v[56:57] op_sel:[0,0] op_sel_hi:[0,1]
    v_pk_mul_f32 v[112:113], v[110:111], v[58:59] op_sel:[0,0] op_sel_hi:[0,1]
    v_pk_mul_f32 v[118:119], v[116:117], v[58:59] op_sel:[0,0] op_sel_hi:[0,1]
    v_pk_fma_f32 v[100:101], v[98:99], v[56:57], v[100:101] op_sel:[1,1,0] op_sel_hi:[1,0,1] neg_lo:[0,1,0]
    v_pk_fma_f32 v[106:107], v[104:105], v[56:57], v[106:107] op_sel:[1,1,0] op_sel_hi:[1,0,1] neg_lo:[0,1,0]
    v_pk_fma_f32 v[112:113], v[110:111], v[58:59], v[112:113] op_sel:[1,1,0] op_sel_hi:[1,0,1] neg_lo:[0,1,0]
    v_pk_fma_f32 v[118:119], v[116:117], v[58:59], v[118:119] op_sel:[1,1,0] op_sel_hi:[1,0,1] neg_lo:[0,1,0]
    v_cvt_pk_bf16_f32 v120, v40, v96
    v_cvt_pk_bf16_f32 v121, v98, v100
    v_cvt_pk_bf16_f32 v122, v42, v102
    v_cvt_pk_bf16_f32 v123, v104, v106
    ds_write_b128 v21, v[120:123] offset:0
    v_cvt_pk_bf16_f32 v124, v41, v97
    v_cvt_pk_bf16_f32 v125, v99, v101
    v_cvt_pk_bf16_f32 v126, v43, v103
    v_cvt_pk_bf16_f32 v127, v105, v107
    ds_write_b128 v21, v[124:127] offset:2176
    v_cvt_pk_bf16_f32 v120, v44, v108
    v_cvt_pk_bf16_f32 v121, v110, v112
    v_cvt_pk_bf16_f32 v122, v46, v114
    v_cvt_pk_bf16_f32 v123, v116, v118
    ds_write_b128 v21, v[120:123] offset:1088
    v_cvt_pk_bf16_f32 v124, v45, v109
    v_cvt_pk_bf16_f32 v125, v111, v113
    v_cvt_pk_bf16_f32 v126, v47, v115
    v_cvt_pk_bf16_f32 v127, v117, v119
    ds_write_b128 v21, v[124:127] offset:3264
    s_waitcnt lgkmcnt(4)
    v_mfma_f32_16x16x32_bf16 v[24:27], v[80:83], v[64:67], 0
    v_mfma_f32_16x16x32_bf16 v[24:27], v[84:87], v[68:71], v[24:27]
    v_mfma_f32_16x16x32_bf16 v[24:27], v[88:91], v[72:75], v[24:27]
    v_mfma_f32_16x16x32_bf16 v[24:27], v[92:95], v[76:79], v[24:27]
    ds_read_b64_tr_b16 v[80:81], v22 offset:0
    ds_read_b64_tr_b16 v[82:83], v22 offset:64
    ds_read_b64_tr_b16 v[84:85], v22 offset:512
    ds_read_b64_tr_b16 v[86:87], v22 offset:576
    ds_read_b64_tr_b16 v[88:89], v22 offset:2176
    ds_read_b64_tr_b16 v[90:91], v22 offset:2240
    ds_read_b64_tr_b16 v[92:93], v22 offset:2688
    ds_read_b64_tr_b16 v[94:95], v22 offset:2752
    v_pk_mul_f32 v[96:97], v[48:49], v[60:61] op_sel:[0,0] op_sel_hi:[0,1]
    v_pk_mul_f32 v[102:103], v[50:51], v[60:61] op_sel:[0,0] op_sel_hi:[0,1]
    v_pk_fma_f32 v[96:97], v[48:49], v[60:61], v[96:97] op_sel:[1,1,0] op_sel_hi:[1,0,1] neg_lo:[0,1,0]
    v_pk_fma_f32 v[102:103], v[50:51], v[60:61], v[102:103] op_sel:[1,1,0] op_sel_hi:[1,0,1] neg_lo:[0,1,0]
    v_pk_mul_f32 v[98:99], v[96:97], v[60:61] op_sel:[0,0] op_sel_hi:[0,1]
    v_pk_mul_f32 v[104:105], v[102:103], v[60:61] op_sel:[0,0] op_sel_hi:[0,1]
    v_pk_fma_f32 v[98:99], v[96:97], v[60:61], v[98:99] op_sel:[1,1,0] op_sel_hi:[1,0,1] neg_lo:[0,1,0]
    v_pk_fma_f32 v[104:105], v[102:103], v[60:61], v[104:105] op_sel:[1,1,0] op_sel_hi:[1,0,1] neg_lo:[0,1,0]
    v_pk_mul_f32 v[100:101], v[98:99], v[60:61] op_sel:[0,0] op_sel_hi:[0,1]
    v_pk_mul_f32 v[106:107], v[104:105], v[60:61] op_sel:[0,0] op_sel_hi:[0,1]
    v_pk_fma_f32 v[100:101], v[98:99], v[60:61], v[100:101] op_sel:[1,1,0] op_sel_hi:[1,0,1] neg_lo:[0,1,0]
    v_pk_fma_f32 v[106:107], v[104:105], v[60:61], v[106:107] op_sel:[1,1,0] op_sel_hi:[1,0,1] neg_lo:[0,1,0]
    v_pk_mul_f32 v[40:41], v[100:101], v[60:61] op_sel:[0,0] op_sel_hi:[0,1]
    v_pk_fma_f32 v[40:41], v[100:101], v[60:61], v[40:41] op_sel:[1,1,0] op_sel_hi:[1,0,1] neg_lo:[0,1,0]
    v_cvt_pk_bf16_f32 v120, v48, v96
    v_cvt_pk_bf16_f32 v121, v98, v100
    v_cvt_pk_bf16_f32 v122, v50, v102
    v_cvt_pk_bf16_f32 v123, v104, v106
    ds_write_b128 v21, v[120:123] offset:0
    v_cvt_pk_bf16_f32 v124, v49, v97
    v_cvt_pk_bf16_f32 v125, v99, v101
    v_cvt_pk_bf16_f32 v126, v51, v103
    v_cvt_pk_bf16_f32 v127, v105, v107
    ds_write_b128 v21, v[124:127] offset:2176
    v_cvt_pk_bf16_f32 v120, v40, v40
    ds_write_b32 v21, v120 offset:1088
    v_cvt_pk_bf16_f32 v124, v41, v41
    ds_write_b32 v21, v124 offset:3264
    s_waitcnt lgkmcnt(4)
    v_mfma_f32_16x16x32_bf16 v[28:31], v[80:83], v[64:67], 0
    v_mfma_f32_16x16x32_bf16 v[28:31], v[84:87], v[68:71], v[28:31]
    v_mfma_f32_16x16x32_bf16 v[28:31], v[88:91], v[72:75], v[28:31]
    v_mfma_f32_16x16x32_bf16 v[28:31], v[92:95], v[76:79], v[28:31]
    ds_read_b64_tr_b16 v[96:97], v22 offset:0
    ds_read_b64_tr_b16 v[98:99], v22 offset:64
    ds_read_b64_tr_b16 v[100:101], v22 offset:512
    ds_read_b64_tr_b16 v[102:103], v22 offset:576
    ds_read_b64_tr_b16 v[104:105], v22 offset:2176
    ds_read_b64_tr_b16 v[106:107], v22 offset:2240
    ds_read_b64_tr_b16 v[108:109], v22 offset:2688
    ds_read_b64_tr_b16 v[110:111], v22 offset:2752
    s_lshl_b32 s28, s6, 13
    s_and_b32 s29, s3, 1
    s_mul_i32 s29, s29, 3072
    s_add_u32 s28, s28, s29
    s_add_u32 s28, s28, 147456
    v_lshl_add_u32 v2, v1, 4, s28
    s_lshl_b32 s28, s3, 2
    s_add_u32 s28, s28, 155216
    v_mov_b32 v3, s28
    v_mov_b32 v4, 1
    ds_write_b128 v2, v[24:27]
    ds_write_b128 v2, v[28:31] offset:1024
    s_waitcnt lgkmcnt(2)
    v_mfma_f32_16x16x32_bf16 v[32:35], v[96:99], v[64:67], 0
    v_mfma_f32_16x16x32_bf16 v[32:35], v[100:103], v[68:71], v[32:35]
    v_mfma_f32_16x16x32_bf16 v[32:35], v[104:107], v[72:75], v[32:35]
    v_mfma_f32_16x16x32_bf16 v[32:35], v[108:111], v[76:79], v[32:35]
    s_nop 7
    ds_write_b128 v2, v[32:35] offset:2048
    ds_write_b32 v3, v4
    s_waitcnt lgkmcnt(0)
    s_cmp_ge_u32 s2, 224
    s_cbranch_scc1 L_tr_post
    s_bfe_u32 s36, s2, 0x20001
    s_and_b32 s28, s2, 1
    s_xor_b32 s28, s28, 1
    s_lshl_b32 s28, s28, 2
    s_add_u32 s36, s36, s28
    s_lshl_b32 s36, s36, 2
    s_bfe_u32 s28, s2, 0x20003
    s_add_u32 s36, s36, s28
    s_lshr_b32 s37, s2, 5
    v_bfe_u32 v2, v1, 2, 2
    v_and_b32 v3, 3, v1
    v_lshrrev_b32 v4, 4, v1
    v_lshl_add_u32 v6, v4, 2, v2
    v_lshlrev_b32 v6, 7, v6
    v_lshl_add_u32 v6, v3, 3, v6
    s_lshl_b32 s42, s3, 12
    s_add_u32 s42, s42, 0
    v_add_u32 v6, s42, v6
    v_lshrrev_b32 v7, 1, v2
    v_and_b32 v4, 1, v4
    v_lshl_or_b32 v7, v4, 1, v7
    v_xor_b32 v5, 0, v7
    v_lshl_add_u32 v16, v5, 5, v6
    v_xor_b32 v5, 1, v7
    v_lshl_add_u32 v17, v5, 5, v6
    v_xor_b32 v5, 2, v7
    v_lshl_add_u32 v18, v5, 5, v6
    v_xor_b32 v5, 3, v7
    v_lshl_add_u32 v10, v5, 5, v6
    v_lshrrev_b32 v2, 3, v1
    v_and_b32 v3, 7, v1
    v_bfe_u32 v4, v1, 4, 2
    v_lshlrev_b32 v4, 1, v4
    v_xor_b32 v3, v3, v4
    v_lshlrev_b32 v2, 10, v2
    v_lshl_add_u32 v28, v3, 4, v2
    v_add_u32 v29, 7168, v28
    v_add_u32 v30, 14336, v28
    v_add_u32 v31, 21504, v28
    s_add_u32 s33, s3, 0
    s_and_b32 s33, s33, 3
    s_mul_i32 s33, s33, 57344
    v_lshl_add_u32 v24, v1, 4, s33
    s_add_u32 s33, s3, 1
    s_and_b32 s33, s33, 3
    s_mul_i32 s33, s33, 57344
    v_lshl_add_u32 v25, v1, 4, s33
    s_add_u32 s33, s3, 2
    s_and_b32 s33, s33, 3
    s_mul_i32 s33, s33, 57344
    v_lshl_add_u32 v26, v1, 4, s33
    s_add_u32 s33, s3, 3
    s_and_b32 s33, s33, 3
    s_mul_i32 s33, s33, 57344
    v_lshl_add_u32 v27, v1, 4, s33
    s_mul_i32 s38, s36, 229376
    s_mul_i32 s31, s3, 14336
    s_add_u32 s38, s38, s31
    s_mul_i32 s41, s3, 458752
    s_lshl_b32 s33, s37, 7
    s_add_u32 s41, s41, s33
    s_add_u32 s41, s41, 32768
    s_mul_i32 s39, s36, 4352
    s_mul_i32 s33, s3, 28
    s_add_u32 s39, s39, s33
    s_add_u32 s39, s39, 14680064
    s_add_u32 s40, s39, 139264
    v_min_u32 v21, 6, v1
    v_lshlrev_b32 v21, 2, v21
    s_mul_i32 s33, s3, 24
    s_sub_u32 s33, 112, s33
    v_mov_b32 v22, s33
    v_cmp_gt_u32 vcc, 7, v1
    s_nop 1
    v_cndmask_b32 v22, v22, v21, vcc
    s_lshl_b32 s28, s3, 2
    s_add_u32 s28, s28, 155152
    v_mov_b32 v19, s28
    s_mov_b32 s7, 1
    s_mov_b32 s28, 8
    s_mov_b32 s31, 0
    s_mov_b32 s30, 49152
    s_barrier
    ds_read_b128 v[32:35], v8 offset:0
    ds_read_b128 v[36:39], v8 offset:2048
    ds_read_b128 v[40:43], v8 offset:4096
    ds_read_b128 v[44:47], v8 offset:6144
    ds_read_b64_tr_b16 v[64:65], v12 offset:0
    ds_read_b64_tr_b16 v[66:67], v12 offset:512
    ds_read_b64_tr_b16 v[68:69], v13 offset:0
    ds_read_b64_tr_b16 v[70:71], v13 offset:512
    ds_read_b64_tr_b16 v[72:73], v14 offset:0
    ds_read_b64_tr_b16 v[74:75], v14 offset:512
    ds_read_b64_tr_b16 v[76:77], v15 offset:0
    ds_read_b64_tr_b16 v[78:79], v15 offset:512
    ds_read_b64_tr_b16 v[80:81], v12 offset:8192
    ds_read_b64_tr_b16 v[82:83], v12 offset:8704
    ds_read_b64_tr_b16 v[84:85], v13 offset:8192
    ds_read_b64_tr_b16 v[86:87], v13 offset:8704
    ds_read_b64_tr_b16 v[88:89], v14 offset:8192
    ds_read_b64_tr_b16 v[90:91], v14 offset:8704
    ds_read_b64_tr_b16 v[92:93], v15 offset:8192
    ds_read_b64_tr_b16 v[94:95], v15 offset:8704
L_g1_loop:
    s_add_u32 s7, s7, 1
    s_cmp_eq_u32 s7, 3
    s_cselect_b32 s29, 4294868992, s30
    s_cselect_b32 s7, 0, s7
    s_waitcnt lgkmcnt(14)
    v_mfma_f32_16x16x32_bf16 v[128:131], v[64:67], v[32:35], v[128:131]
    v_mfma_f32_16x16x32_bf16 v[132:135], v[64:67], v[36:39], v[132:135]
    v_mfma_f32_16x16x32_bf16 v[136:139], v[64:67], v[40:43], v[136:139]
    ds_read_b128 v[48:51], v9 offset:0
    v_mfma_f32_16x16x32_bf16 v[140:143], v[64:67], v[44:47], v[140:143]
    ds_read_b128 v[52:55], v9 offset:2048
    s_waitcnt lgkmcnt(14)
    v_mfma_f32_16x16x32_bf16 v[144:147], v[68:71], v[32:35], v[144:147]
    ds_read_b128 v[56:59], v9 offset:4096
    v_mfma_f32_16x16x32_bf16 v[148:151], v[68:71], v[36:39], v[148:151]
    ds_read_b128 v[60:63], v9 offset:6144
    v_mfma_f32_16x16x32_bf16 v[152:155], v[68:71], v[40:43], v[152:155]
    ds_read_b64_tr_b16 v[96:97], v12 offset:4096
    v_mfma_f32_16x16x32_bf16 v[156:159], v[68:71], v[44:47], v[156:159]
    ds_read_b64_tr_b16 v[98:99], v12 offset:4608
    s_waitcnt lgkmcnt(15)
    v_mfma_f32_16x16x32_bf16 v[160:163], v[72:75], v[32:35], v[160:163]
    ds_read_b64_tr_b16 v[100:101], v13 offset:4096
    v_mfma_f32_16x16x32_bf16 v[164:167], v[72:75], v[36:39], v[164:167]
    ds_read_b64_tr_b16 v[102:103], v13 offset:4608
    v_mfma_f32_16x16x32_bf16 v[168:171], v[72:75], v[40:43], v[168:171]
    ds_read_b64_tr_b16 v[104:105], v14 offset:4096
    v_mfma_f32_16x16x32_bf16 v[172:175], v[72:75], v[44:47], v[172:175]
    ds_read_b64_tr_b16 v[106:107], v14 offset:4608
    s_waitcnt lgkmcnt(15)
    v_mfma_f32_16x16x32_bf16 v[176:179], v[76:79], v[32:35], v[176:179]
    ds_read_b64_tr_b16 v[108:109], v15 offset:4096
    v_mfma_f32_16x16x32_bf16 v[180:183], v[76:79], v[36:39], v[180:183]
    ds_read_b64_tr_b16 v[110:111], v15 offset:4608
    v_mfma_f32_16x16x32_bf16 v[184:187], v[76:79], v[40:43], v[184:187]
    ds_read_b64_tr_b16 v[112:113], v12 offset:12288
    v_mfma_f32_16x16x32_bf16 v[188:191], v[76:79], v[44:47], v[188:191]
    ds_read_b64_tr_b16 v[114:115], v12 offset:12800
    s_waitcnt lgkmcnt(15)
    v_mfma_f32_16x16x32_bf16 v[192:195], v[80:83], v[32:35], v[192:195]
    ds_read_b64_tr_b16 v[116:117], v13 offset:12288
    v_mfma_f32_16x16x32_bf16 v[196:199], v[80:83], v[36:39], v[196:199]
    ds_read_b64_tr_b16 v[118:119], v13 offset:12800
    v_mfma_f32_16x16x32_bf16 v[200:203], v[80:83], v[40:43], v[200:203]
    ds_read_b64_tr_b16 v[120:121], v14 offset:12288
    v_mfma_f32_16x16x32_bf16 v[204:207], v[80:83], v[44:47], v[204:207]
    ds_read_b64_tr_b16 v[122:123], v14 offset:12800
    s_waitcnt lgkmcnt(15)
    v_mfma_f32_16x16x32_bf16 v[208:211], v[84:87], v[32:35], v[208:211]
    ds_read_b64_tr_b16 v[124:125], v15 offset:12288
    v_mfma_f32_16x16x32_bf16 v[212:215], v[84:87], v[36:39], v[212:215]
    ds_read_b64_tr_b16 v[126:127], v15 offset:12800
    v_mfma_f32_16x16x32_bf16 v[216:219], v[84:87], v[40:43], v[216:219]
    v_mfma_f32_16x16x32_bf16 v[220:223], v[84:87], v[44:47], v[220:223]
    s_waitcnt lgkmcnt(15)
    v_mfma_f32_16x16x32_bf16 v[224:227], v[88:91], v[32:35], v[224:227]
    v_add_u32 v8, s29, v8
    v_add_u32 v9, s29, v9
    v_mfma_f32_16x16x32_bf16 v[228:231], v[88:91], v[36:39], v[228:231]
    v_add_u32 v12, s29, v12
    v_add_u32 v13, s29, v13
    v_mfma_f32_16x16x32_bf16 v[232:235], v[88:91], v[40:43], v[232:235]
    v_add_u32 v14, s29, v14
    v_add_u32 v15, s29, v15
    v_mfma_f32_16x16x32_bf16 v[236:239], v[88:91], v[44:47], v[236:239]
    s_sub_u32 s28, s28, 1
    s_cmp_eq_u32 s28, 0
    s_waitcnt lgkmcnt(15)
    v_mfma_f32_16x16x32_bf16 v[240:243], v[92:95], v[32:35], v[240:243]
    v_mfma_f32_16x16x32_bf16 v[244:247], v[92:95], v[36:39], v[244:247]
    v_mfma_f32_16x16x32_bf16 v[248:251], v[92:95], v[40:43], v[248:251]
    v_mfma_f32_16x16x32_bf16 v[252:255], v[92:95], v[44:47], v[252:255]
    s_waitcnt lgkmcnt(0)
    v_mfma_f32_16x16x32_bf16 v[128:131], v[96:99], v[48:51], v[128:131]
    v_mfma_f32_16x16x32_bf16 v[132:135], v[96:99], v[52:55], v[132:135]
    s_barrier
    s_cbranch_scc1 L_g1_last
    ds_read_b128 v[32:35], v8 offset:0
    v_mfma_f32_16x16x32_bf16 v[136:139], v[96:99], v[56:59], v[136:139]
    ds_read_b128 v[36:39], v8 offset:2048
    v_mfma_f32_16x16x32_bf16 v[140:143], v[96:99], v[60:63], v[140:143]
    ds_read_b128 v[40:43], v8 offset:4096
    v_mfma_f32_16x16x32_bf16 v[144:147], v[100:103], v[48:51], v[144:147]
    ds_read_b128 v[44:47], v8 offset:6144
    v_mfma_f32_16x16x32_bf16 v[148:151], v[100:103], v[52:55], v[148:151]
    ds_read_b64_tr_b16 v[64:65], v12 offset:0
    v_mfma_f32_16x16x32_bf16 v[152:155], v[100:103], v[56:59], v[152:155]
    ds_read_b64_tr_b16 v[66:67], v12 offset:512
    v_mfma_f32_16x16x32_bf16 v[156:159], v[100:103], v[60:63], v[156:159]
    ds_read_b64_tr_b16 v[68:69], v13 offset:0
    v_mfma_f32_16x16x32_bf16 v[160:163], v[104:107], v[48:51], v[160:163]
    ds_read_b64_tr_b16 v[70:71], v13 offset:512
    v_mfma_f32_16x16x32_bf16 v[164:167], v[104:107], v[52:55], v[164:167]
    ds_read_b64_tr_b16 v[72:73], v14 offset:0
    v_mfma_f32_16x16x32_bf16 v[168:171], v[104:107], v[56:59], v[168:171]
    ds_read_b64_tr_b16 v[74:75], v14 offset:512
    v_mfma_f32_16x16x32_bf16 v[172:175], v[104:107], v[60:63], v[172:175]
    ds_read_b64_tr_b16 v[76:77], v15 offset:0
    v_mfma_f32_16x16x32_bf16 v[176:179], v[108:111], v[48:51], v[176:179]
    ds_read_b64_tr_b16 v[78:79], v15 offset:512
    v_mfma_f32_16x16x32_bf16 v[180:183], v[108:111], v[52:55], v[180:183]
    ds_read_b64_tr_b16 v[80:81], v12 offset:8192
    v_mfma_f32_16x16x32_bf16 v[184:187], v[108:111], v[56:59], v[184:187]
    ds_read_b64_tr_b16 v[82:83], v12 offset:8704
    v_mfma_f32_16x16x32_bf16 v[188:191], v[108:111], v[60:63], v[188:191]
    ds_read_b64_tr_b16 v[84:85], v13 offset:8192
    v_mfma_f32_16x16x32_bf16 v[192:195], v[112:115], v[48:51], v[192:195]
    ds_read_b64_tr_b16 v[86:87], v13 offset:8704
    v_mfma_f32_16x16x32_bf16 v[196:199], v[112:115], v[52:55], v[196:199]
    ds_read_b64_tr_b16 v[88:89], v14 offset:8192
    v_mfma_f32_16x16x32_bf16 v[200:203], v[112:115], v[56:59], v[200:203]
    ds_read_b64_tr_b16 v[90:91], v14 offset:8704
    v_mfma_f32_16x16x32_bf16 v[204:207], v[112:115], v[60:63], v[204:207]
    ds_read_b64_tr_b16 v[92:93], v15 offset:8192
    v_mfma_f32_16x16x32_bf16 v[208:211], v[116:119], v[48:51], v[208:211]
    ds_read_b64_tr_b16 v[94:95], v15 offset:8704
    v_mfma_f32_16x16x32_bf16 v[212:215], v[116:119], v[52:55], v[212:215]
    v_mfma_f32_16x16x32_bf16 v[216:219], v[116:119], v[56:59], v[216:219]
    v_mfma_f32_16x16x32_bf16 v[220:223], v[116:119], v[60:63], v[220:223]
    v_mfma_f32_16x16x32_bf16 v[224:227], v[120:123], v[48:51], v[224:227]
    v_mfma_f32_16x16x32_bf16 v[228:231], v[120:123], v[52:55], v[228:231]
    v_mfma_f32_16x16x32_bf16 v[232:235], v[120:123], v[56:59], v[232:235]
    v_mfma_f32_16x16x32_bf16 v[236:239], v[120:123], v[60:63], v[236:239]
    v_mfma_f32_16x16x32_bf16 v[240:243], v[124:127], v[48:51], v[240:243]
    v_mfma_f32_16x16x32_bf16 v[244:247], v[124:127], v[52:55], v[244:247]
    v_mfma_f32_16x16x32_bf16 v[248:251], v[124:127], v[56:59], v[248:251]
    v_mfma_f32_16x16x32_bf16 v[252:255], v[124:127], v[60:63], v[252:255]
    s_branch L_g1_loop
L_g1_last:
    v_mfma_f32_16x16x32_bf16 v[136:139], v[96:99], v[56:59], v[136:139]
    v_mfma_f32_16x16x32_bf16 v[140:143], v[96:99], v[60:63], v[140:143]
    v_mfma_f32_16x16x32_bf16 v[144:147], v[100:103], v[48:51], v[144:147]
    v_mfma_f32_16x16x32_bf16 v[148:151], v[100:103], v[52:55], v[148:151]
    v_mfma_f32_16x16x32_bf16 v[152:155], v[100:103], v[56:59], v[152:155]
    v_mfma_f32_16x16x32_bf16 v[156:159], v[100:103], v[60:63], v[156:159]
    v_mfma_f32_16x16x32_bf16 v[160:163], v[104:107], v[48:51], v[160:163]
    v_mfma_f32_16x16x32_bf16 v[164:167], v[104:107], v[52:55], v[164:167]
    v_mfma_f32_16x16x32_bf16 v[168:171], v[104:107], v[56:59], v[168:171]
    v_mfma_f32_16x16x32_bf16 v[172:175], v[104:107], v[60:63], v[172:175]
    v_mfma_f32_16x16x32_bf16 v[176:179], v[108:111], v[48:51], v[176:179]
    v_mfma_f32_16x16x32_bf16 v[180:183], v[108:111], v[52:55], v[180:183]
    v_mfma_f32_16x16x32_bf16 v[184:187], v[108:111], v[56:59], v[184:187]
    v_mfma_f32_16x16x32_bf16 v[188:191], v[108:111], v[60:63], v[188:191]
    v_mfma_f32_16x16x32_bf16 v[192:195], v[112:115], v[48:51], v[192:195]
    v_mfma_f32_16x16x32_bf16 v[196:199], v[112:115], v[52:55], v[196:199]
    v_mfma_f32_16x16x32_bf16 v[200:203], v[112:115], v[56:59], v[200:203]
    v_mfma_f32_16x16x32_bf16 v[204:207], v[112:115], v[60:63], v[204:207]
    v_mfma_f32_16x16x32_bf16 v[208:211], v[116:119], v[48:51], v[208:211]
    v_mfma_f32_16x16x32_bf16 v[212:215], v[116:119], v[52:55], v[212:215]
    v_mfma_f32_16x16x32_bf16 v[216:219], v[116:119], v[56:59], v[216:219]
    v_mfma_f32_16x16x32_bf16 v[220:223], v[116:119], v[60:63], v[220:223]
    v_mfma_f32_16x16x32_bf16 v[224:227], v[120:123], v[48:51], v[224:227]
    v_mfma_f32_16x16x32_bf16 v[228:231], v[120:123], v[52:55], v[228:231]
    v_mfma_f32_16x16x32_bf16 v[232:235], v[120:123], v[56:59], v[232:235]
    v_mfma_f32_16x16x32_bf16 v[236:239], v[120:123], v[60:63], v[236:239]
    v_mfma_f32_16x16x32_bf16 v[240:243], v[124:127], v[48:51], v[240:243]
    v_mfma_f32_16x16x32_bf16 v[244:247], v[124:127], v[52:55], v[244:247]
    v_mfma_f32_16x16x32_bf16 v[248:251], v[124:127], v[56:59], v[248:251]
    v_mfma_f32_16x16x32_bf16 v[252:255], v[124:127], v[60:63], v[252:255]
    s_mov_b32 s6, 3216550459
    s_mov_b32 s7, 3216550459
    s_lshl_b32 s28, s4, 4
    s_lshl_b32 s29, s3, 2
    s_add_u32 s28, s28, s29
    s_mul_i32 s28, s28, 56
    s_lshl_b32 s29, s5, 1
    s_add_u32 s28, s28, s29
    s_lshl_b32 s28, s28, 10
    s_add_u32 s29, s28, 57344
    s_add_u32 s30, s28, 114688
    s_add_u32 s31, s28, 172032
    v_lshlrev_b32 v2, 4, v1
    s_lshl_b32 s32, s4, 2
    s_add_u32 s32, s32, s3
    s_mul_i32 s32, s32, 4352
    s_lshl_b32 s33, s5, 2
    s_add_u32 s32, s32, s33
    s_add_u32 s32, s32, 14680064
    s_add_u32 s33, s32, 139264
    v_pk_mul_f32 v[32:33], v[128:129], s[6:7]
    ds_read_b64_tr_b16 v[64:65], v16 offset:0
    v_pk_mul_f32 v[34:35], v[130:131], s[6:7]
    ds_read_b64_tr_b16 v[66:67], v16 offset:2048
    v_pk_mul_f32 v[36:37], v[144:145], s[6:7]
    ds_read_b64_tr_b16 v[68:69], v17 offset:0
    v_pk_mul_f32 v[38:39], v[146:147], s[6:7]
    ds_read_b64_tr_b16 v[70:71], v17 offset:2048
    v_exp_f32 v32, v32
    ds_read_b64_tr_b16 v[72:73], v18 offset:0
    v_exp_f32 v33, v33
    ds_read_b64_tr_b16 v[74:75], v18 offset:2048
    v_exp_f32 v34, v34
    ds_read_b64_tr_b16 v[76:77], v10 offset:0
    v_exp_f32 v35, v35
    ds_read_b64_tr_b16 v[78:79], v10 offset:2048
    v_exp_f32 v36, v36
    ds_read_b64_tr_b16 v[80:81], v16 offset:16384
    v_exp_f32 v37, v37
    ds_read_b64_tr_b16 v[82:83], v16 offset:18432
    v_exp_f32 v38, v38
    ds_read_b64_tr_b16 v[84:85], v17 offset:16384
    v_exp_f32 v39, v39
    ds_read_b64_tr_b16 v[86:87], v17 offset:18432
    v_pk_mul_f32 v[192:193], v[128:129], v[192:193]
    ds_read_b64_tr_b16 v[88:89], v18 offset:16384
    v_pk_mul_f32 v[194:195], v[130:131], v[194:195]
    ds_read_b64_tr_b16 v[90:91], v18 offset:18432
    v_pk_mul_f32 v[208:209], v[144:145], v[208:209]
    ds_read_b64_tr_b16 v[92:93], v10 offset:16384
    v_pk_mul_f32 v[210:211], v[146:147], v[210:211]
    ds_read_b64_tr_b16 v[94:95], v10 offset:18432
    v_pk_add_f32 v[32:33], v[32:33], 1.0 op_sel_hi:[1,0]
    ds_read_b64_tr_b16 v[96:97], v16 offset:32768
    v_pk_add_f32 v[34:35], v[34:35], 1.0 op_sel_hi:[1,0]
    ds_read_b64_tr_b16 v[98:99], v16 offset:34816
    v_pk_add_f32 v[36:37], v[36:37], 1.0 op_sel_hi:[1,0]
    ds_read_b64_tr_b16 v[100:101], v17 offset:32768
    v_pk_add_f32 v[38:39], v[38:39], 1.0 op_sel_hi:[1,0]
    ds_read_b64_tr_b16 v[102:103], v17 offset:34816
    v_rcp_f32 v32, v32
    ds_read_b64_tr_b16 v[104:105], v18 offset:32768
    v_rcp_f32 v33, v33
    ds_read_b64_tr_b16 v[106:107], v18 offset:34816
    v_rcp_f32 v34, v34
    ds_read_b64_tr_b16 v[108:109], v10 offset:32768
    v_rcp_f32 v35, v35
    ds_read_b64_tr_b16 v[110:111], v10 offset:34816
    v_rcp_f32 v36, v36
    v_rcp_f32 v37, v37
    v_rcp_f32 v38, v38
    v_rcp_f32 v39, v39
    s_nop 0
    v_pk_mul_f32 v[192:193], v[192:193], v[32:33]
    v_pk_mul_f32 v[194:195], v[194:195], v[34:35]
    v_pk_mul_f32 v[208:209], v[208:209], v[36:37]
    v_pk_mul_f32 v[210:211], v[210:211], v[38:39]
    v_cvt_pk_bf16_f32 v40, v192, v193
    v_cvt_pk_bf16_f32 v41, v194, v195
    v_cvt_pk_bf16_f32 v42, v208, v209
    v_cvt_pk_bf16_f32 v43, v210, v211
    buffer_store_dwordx4 v[40:43], v2, s[20:23], s28 offen offset:0 sc1
    v_pk_mul_f32 v[48:49], v[132:133], s[6:7]
    v_pk_mul_f32 v[50:51], v[134:135], s[6:7]
    v_pk_mul_f32 v[52:53], v[148:149], s[6:7]
    v_pk_mul_f32 v[54:55], v[150:151], s[6:7]
    v_exp_f32 v48, v48
    v_exp_f32 v49, v49
    v_exp_f32 v50, v50
    v_exp_f32 v51, v51
    v_exp_f32 v52, v52
    v_exp_f32 v53, v53
    v_exp_f32 v54, v54
    v_exp_f32 v55, v55
    v_pk_mul_f32 v[196:197], v[132:133], v[196:197]
    v_pk_mul_f32 v[198:199], v[134:135], v[198:199]
    v_pk_mul_f32 v[212:213], v[148:149], v[212:213]
    v_pk_mul_f32 v[214:215], v[150:151], v[214:215]
    v_pk_add_f32 v[48:49], v[48:49], 1.0 op_sel_hi:[1,0]
    v_pk_add_f32 v[50:51], v[50:51], 1.0 op_sel_hi:[1,0]
    v_pk_add_f32 v[52:53], v[52:53], 1.0 op_sel_hi:[1,0]
    v_pk_add_f32 v[54:55], v[54:55], 1.0 op_sel_hi:[1,0]
    v_rcp_f32 v48, v48
    v_rcp_f32 v49, v49
    v_rcp_f32 v50, v50
    v_rcp_f32 v51, v51
    v_rcp_f32 v52, v52
    v_rcp_f32 v53, v53
    v_rcp_f32 v54, v54
    v_rcp_f32 v55, v55
    s_nop 0
    v_pk_mul_f32 v[196:197], v[196:197], v[48:49]
    v_pk_mul_f32 v[198:199], v[198:199], v[50:51]
    v_pk_mul_f32 v[212:213], v[212:213], v[52:53]
    v_pk_mul_f32 v[214:215], v[214:215], v[54:55]
    v_cvt_pk_bf16_f32 v56, v196, v197
    v_cvt_pk_bf16_f32 v57, v198, v199
    v_cvt_pk_bf16_f32 v58, v212, v213
    v_cvt_pk_bf16_f32 v59, v214, v215
    buffer_store_dwordx4 v[56:59], v2, s[20:23], s29 offen offset:0 sc1
    v_pk_mul_f32 v[32:33], v[136:137], s[6:7]
    v_pk_mul_f32 v[34:35], v[138:139], s[6:7]
    v_pk_mul_f32 v[36:37], v[152:153], s[6:7]
    v_pk_mul_f32 v[38:39], v[154:155], s[6:7]
    v_exp_f32 v32, v32
    v_exp_f32 v33, v33
    v_exp_f32 v34, v34
    v_exp_f32 v35, v35
    v_exp_f32 v36, v36
    v_exp_f32 v37, v37
    v_exp_f32 v38, v38
    v_exp_f32 v39, v39
    v_pk_mul_f32 v[200:201], v[136:137], v[200:201]
    v_pk_mul_f32 v[202:203], v[138:139], v[202:203]
    v_pk_mul_f32 v[216:217], v[152:153], v[216:217]
    v_pk_mul_f32 v[218:219], v[154:155], v[218:219]
    v_pk_add_f32 v[32:33], v[32:33], 1.0 op_sel_hi:[1,0]
    v_pk_add_f32 v[34:35], v[34:35], 1.0 op_sel_hi:[1,0]
    v_pk_add_f32 v[36:37], v[36:37], 1.0 op_sel_hi:[1,0]
    v_pk_add_f32 v[38:39], v[38:39], 1.0 op_sel_hi:[1,0]
    v_rcp_f32 v32, v32
    v_rcp_f32 v33, v33
    v_rcp_f32 v34, v34
    v_rcp_f32 v35, v35
    v_rcp_f32 v36, v36
    v_rcp_f32 v37, v37
    v_rcp_f32 v38, v38
    v_rcp_f32 v39, v39
    s_nop 0
    v_pk_mul_f32 v[200:201], v[200:201], v[32:33]
    v_pk_mul_f32 v[202:203], v[202:203], v[34:35]
    v_pk_mul_f32 v[216:217], v[216:217], v[36:37]
    v_pk_mul_f32 v[218:219], v[218:219], v[38:39]
    v_cvt_pk_bf16_f32 v40, v200, v201
    v_cvt_pk_bf16_f32 v41, v202, v203
    v_cvt_pk_bf16_f32 v42, v216, v217
    v_cvt_pk_bf16_f32 v43, v218, v219
    buffer_store_dwordx4 v[40:43], v2, s[20:23], s30 offen offset:0 sc1
    v_pk_mul_f32 v[48:49], v[140:141], s[6:7]
    v_pk_mul_f32 v[50:51], v[142:143], s[6:7]
    v_pk_mul_f32 v[52:53], v[156:157], s[6:7]
    v_pk_mul_f32 v[54:55], v[158:159], s[6:7]
    v_exp_f32 v48, v48
    v_exp_f32 v49, v49
    v_exp_f32 v50, v50
    v_exp_f32 v51, v51
    v_exp_f32 v52, v52
    v_exp_f32 v53, v53
    v_exp_f32 v54, v54
    v_exp_f32 v55, v55
    v_pk_mul_f32 v[204:205], v[140:141], v[204:205]
    v_pk_mul_f32 v[206:207], v[142:143], v[206:207]
    v_pk_mul_f32 v[220:221], v[156:157], v[220:221]
    v_pk_mul_f32 v[222:223], v[158:159], v[222:223]
    v_pk_add_f32 v[48:49], v[48:49], 1.0 op_sel_hi:[1,0]
    v_pk_add_f32 v[50:51], v[50:51], 1.0 op_sel_hi:[1,0]
    v_pk_add_f32 v[52:53], v[52:53], 1.0 op_sel_hi:[1,0]
    v_pk_add_f32 v[54:55], v[54:55], 1.0 op_sel_hi:[1,0]
    v_rcp_f32 v48, v48
    v_rcp_f32 v49, v49
    v_rcp_f32 v50, v50
    v_rcp_f32 v51, v51
    v_rcp_f32 v52, v52
    v_rcp_f32 v53, v53
    v_rcp_f32 v54, v54
    v_rcp_f32 v55, v55
    s_nop 0
    v_pk_mul_f32 v[204:205], v[204:205], v[48:49]
    v_pk_mul_f32 v[206:207], v[206:207], v[50:51]
    v_pk_mul_f32 v[220:221], v[220:221], v[52:53]
    v_pk_mul_f32 v[222:223], v[222:223], v[54:55]
    v_cvt_pk_bf16_f32 v56, v204, v205
    v_cvt_pk_bf16_f32 v57, v206, v207
    v_cvt_pk_bf16_f32 v58, v220, v221
    v_cvt_pk_bf16_f32 v59, v222, v223
    buffer_store_dwordx4 v[56:59], v2, s[20:23], s31 offen offset:0 sc1
    v_pk_mul_f32 v[32:33], v[160:161], s[6:7]
    v_pk_mul_f32 v[34:35], v[162:163], s[6:7]
    v_pk_mul_f32 v[36:37], v[176:177], s[6:7]
    v_pk_mul_f32 v[38:39], v[178:179], s[6:7]
    v_exp_f32 v32, v32
    v_exp_f32 v33, v33
    v_exp_f32 v34, v34
    v_exp_f32 v35, v35
    v_exp_f32 v36, v36
    v_exp_f32 v37, v37
    v_exp_f32 v38, v38
    v_exp_f32 v39, v39
    v_pk_mul_f32 v[224:225], v[160:161], v[224:225]
    v_pk_mul_f32 v[226:227], v[162:163], v[226:227]
    v_pk_mul_f32 v[240:241], v[176:177], v[240:241]
    v_pk_mul_f32 v[242:243], v[178:179], v[242:243]
    v_pk_add_f32 v[32:33], v[32:33], 1.0 op_sel_hi:[1,0]
    v_pk_add_f32 v[34:35], v[34:35], 1.0 op_sel_hi:[1,0]
    v_pk_add_f32 v[36:37], v[36:37], 1.0 op_sel_hi:[1,0]
    v_pk_add_f32 v[38:39], v[38:39], 1.0 op_sel_hi:[1,0]
    v_rcp_f32 v32, v32
    v_rcp_f32 v33, v33
    v_rcp_f32 v34, v34
    v_rcp_f32 v35, v35
    v_rcp_f32 v36, v36
    v_rcp_f32 v37, v37
    v_rcp_f32 v38, v38
    v_rcp_f32 v39, v39
    s_nop 0
    v_pk_mul_f32 v[224:225], v[224:225], v[32:33]
    v_pk_mul_f32 v[226:227], v[226:227], v[34:35]
    v_pk_mul_f32 v[240:241], v[240:241], v[36:37]
    v_pk_mul_f32 v[242:243], v[242:243], v[38:39]
    v_cvt_pk_bf16_f32 v40, v224, v225
    v_cvt_pk_bf16_f32 v41, v226, v227
    v_cvt_pk_bf16_f32 v42, v240, v241
    v_cvt_pk_bf16_f32 v43, v242, v243
    buffer_store_dwordx4 v[40:43], v2, s[20:23], s28 offen offset:1024 sc1
    v_pk_mul_f32 v[48:49], v[164:165], s[6:7]
    v_pk_mul_f32 v[50:51], v[166:167], s[6:7]
    v_pk_mul_f32 v[52:53], v[180:181], s[6:7]
    v_pk_mul_f32 v[54:55], v[182:183], s[6:7]
    v_exp_f32 v48, v48
    v_exp_f32 v49, v49
    v_exp_f32 v50, v50
    v_exp_f32 v51, v51
    v_exp_f32 v52, v52
    v_exp_f32 v53, v53
    v_exp_f32 v54, v54
    v_exp_f32 v55, v55
    v_pk_mul_f32 v[228:229], v[164:165], v[228:229]
    v_pk_mul_f32 v[230:231], v[166:167], v[230:231]
    v_pk_mul_f32 v[244:245], v[180:181], v[244:245]
    v_pk_mul_f32 v[246:247], v[182:183], v[246:247]
    v_pk_add_f32 v[48:49], v[48:49], 1.0 op_sel_hi:[1,0]
    v_pk_add_f32 v[50:51], v[50:51], 1.0 op_sel_hi:[1,0]
    v_pk_add_f32 v[52:53], v[52:53], 1.0 op_sel_hi:[1,0]
    v_pk_add_f32 v[54:55], v[54:55], 1.0 op_sel_hi:[1,0]
    v_rcp_f32 v48, v48
    v_rcp_f32 v49, v49
    v_rcp_f32 v50, v50
    v_rcp_f32 v51, v51
    v_rcp_f32 v52, v52
    v_rcp_f32 v53, v53
    v_rcp_f32 v54, v54
    v_rcp_f32 v55, v55
    s_nop 0
    v_pk_mul_f32 v[228:229], v[228:229], v[48:49]
    v_pk_mul_f32 v[230:231], v[230:231], v[50:51]
    v_pk_mul_f32 v[244:245], v[244:245], v[52:53]
    v_pk_mul_f32 v[246:247], v[246:247], v[54:55]
    v_cvt_pk_bf16_f32 v56, v228, v229
    v_cvt_pk_bf16_f32 v57, v230, v231
    v_cvt_pk_bf16_f32 v58, v244, v245
    v_cvt_pk_bf16_f32 v59, v246, v247
    buffer_store_dwordx4 v[56:59], v2, s[20:23], s29 offen offset:1024 sc1
    v_pk_mul_f32 v[32:33], v[168:169], s[6:7]
    v_pk_mul_f32 v[34:35], v[170:171], s[6:7]
    v_pk_mul_f32 v[36:37], v[184:185], s[6:7]
    v_pk_mul_f32 v[38:39], v[186:187], s[6:7]
    v_exp_f32 v32, v32
    v_exp_f32 v33, v33
    v_exp_f32 v34, v34
    v_exp_f32 v35, v35
    v_exp_f32 v36, v36
    v_exp_f32 v37, v37
    v_exp_f32 v38, v38
    v_exp_f32 v39, v39
    v_pk_mul_f32 v[232:233], v[168:169], v[232:233]
    v_pk_mul_f32 v[234:235], v[170:171], v[234:235]
    v_pk_mul_f32 v[248:249], v[184:185], v[248:249]
    v_pk_mul_f32 v[250:251], v[186:187], v[250:251]
    v_pk_add_f32 v[32:33], v[32:33], 1.0 op_sel_hi:[1,0]
    v_pk_add_f32 v[34:35], v[34:35], 1.0 op_sel_hi:[1,0]
    v_pk_add_f32 v[36:37], v[36:37], 1.0 op_sel_hi:[1,0]
    v_pk_add_f32 v[38:39], v[38:39], 1.0 op_sel_hi:[1,0]
    v_rcp_f32 v32, v32
    v_rcp_f32 v33, v33
    v_rcp_f32 v34, v34
    v_rcp_f32 v35, v35
    v_rcp_f32 v36, v36
    v_rcp_f32 v37, v37
    v_rcp_f32 v38, v38
    v_rcp_f32 v39, v39
    s_nop 0
    v_pk_mul_f32 v[232:233], v[232:233], v[32:33]
    v_pk_mul_f32 v[234:235], v[234:235], v[34:35]
    v_pk_mul_f32 v[248:249], v[248:249], v[36:37]
    v_pk_mul_f32 v[250:251], v[250:251], v[38:39]
    v_cvt_pk_bf16_f32 v40, v232, v233
    v_cvt_pk_bf16_f32 v41, v234, v235
    v_cvt_pk_bf16_f32 v42, v248, v249
    v_cvt_pk_bf16_f32 v43, v250, v251
    s_waitcnt vmcnt(2)
    v_mov_b32 v4, 1
    v_mov_b32 v3, 0
    s_mov_b64 exec, 1
    buffer_store_dword v4, v3, s[20:23], s32 offen sc1
    s_mov_b64 exec, -1
    buffer_store_dwordx4 v[40:43], v2, s[20:23], s30 offen offset:1024 sc1
    v_mov_b32 v3, 155176
L_lw_ew1:
    s_sub_u32 s0, s0, 1
    s_cbranch_scc1 L_end
    ds_read_b64 v[4:5], v3
    s_waitcnt lgkmcnt(0)
    v_min_u32 v4, v4, v5
    v_cmp_gt_u32 vcc, 1, v4
    s_cbranch_vccnz L_lw_ew1
    v_pk_mul_f32 v[48:49], v[172:173], s[6:7]
    ds_read_b64_tr_b16 v[112:113], v16 offset:49152
    v_pk_mul_f32 v[50:51], v[174:175], s[6:7]
    ds_read_b64_tr_b16 v[114:115], v16 offset:51200
    v_pk_mul_f32 v[52:53], v[188:189], s[6:7]
    ds_read_b64_tr_b16 v[116:117], v17 offset:49152
    v_pk_mul_f32 v[54:55], v[190:191], s[6:7]
    ds_read_b64_tr_b16 v[118:119], v17 offset:51200
    v_exp_f32 v48, v48
    ds_read_b64_tr_b16 v[120:121], v18 offset:49152
    v_exp_f32 v49, v49
    ds_read_b64_tr_b16 v[122:123], v18 offset:51200
    v_exp_f32 v50, v50
    ds_read_b64_tr_b16 v[124:125], v10 offset:49152
    v_exp_f32 v51, v51
    ds_read_b64_tr_b16 v[126:127], v10 offset:51200
    v_exp_f32 v52, v52
    v_add_u32 v16, 65536, v16
    v_exp_f32 v53, v53
    v_add_u32 v17, 65536, v17
    v_exp_f32 v54, v54
    v_add_u32 v18, 65536, v18
    v_exp_f32 v55, v55
    v_add_u32 v10, 65536, v10
    v_pk_mul_f32 v[236:237], v[172:173], v[236:237]
    ds_read_b64_tr_b16 v[128:129], v16 offset:0
    v_pk_mul_f32 v[238:239], v[174:175], v[238:239]
    ds_read_b64_tr_b16 v[130:131], v16 offset:2048
    v_pk_mul_f32 v[252:253], v[188:189], v[252:253]
    ds_read_b64_tr_b16 v[132:133], v17 offset:0
    v_pk_mul_f32 v[254:255], v[190:191], v[254:255]
    ds_read_b64_tr_b16 v[134:135], v17 offset:2048
    v_pk_add_f32 v[48:49], v[48:49], 1.0 op_sel_hi:[1,0]
    ds_read_b64_tr_b16 v[136:137], v18 offset:0
    v_pk_add_f32 v[50:51], v[50:51], 1.0 op_sel_hi:[1,0]
    ds_read_b64_tr_b16 v[138:139], v18 offset:2048
    v_pk_add_f32 v[52:53], v[52:53], 1.0 op_sel_hi:[1,0]
    ds_read_b64_tr_b16 v[140:141], v10 offset:0
    v_pk_add_f32 v[54:55], v[54:55], 1.0 op_sel_hi:[1,0]
    ds_read_b64_tr_b16 v[142:143], v10 offset:2048
    v_rcp_f32 v48, v48
    ds_read_b64_tr_b16 v[144:145], v16 offset:16384
    v_rcp_f32 v49, v49
    ds_read_b64_tr_b16 v[146:147], v16 offset:18432
    v_rcp_f32 v50, v50
    ds_read_b64_tr_b16 v[148:149], v17 offset:16384
    v_rcp_f32 v51, v51
    ds_read_b64_tr_b16 v[150:151], v17 offset:18432
    v_rcp_f32 v52, v52
    ds_read_b64_tr_b16 v[152:153], v18 offset:16384
    v_rcp_f32 v53, v53
    ds_read_b64_tr_b16 v[154:155], v18 offset:18432
    v_rcp_f32 v54, v54
    ds_read_b64_tr_b16 v[156:157], v10 offset:16384
    v_rcp_f32 v55, v55
    ds_read_b64_tr_b16 v[158:159], v10 offset:18432
    s_nop 0
    v_pk_mul_f32 v[236:237], v[236:237], v[48:49]
    v_pk_mul_f32 v[238:239], v[238:239], v[50:51]
    v_pk_mul_f32 v[252:253], v[252:253], v[52:53]
    v_pk_mul_f32 v[254:255], v[254:255], v[54:55]
    v_cvt_pk_bf16_f32 v56, v236, v237
    v_cvt_pk_bf16_f32 v57, v238, v239
    v_cvt_pk_bf16_f32 v58, v252, v253
    v_cvt_pk_bf16_f32 v59, v254, v255
    buffer_store_dwordx4 v[56:59], v2, s[20:23], s31 offen offset:1024 sc1
    v_mov_b32 v20, 7
    ds_write_b32 v19, v20
    s_mov_b32 s35, s33
L_g2:
    s_waitcnt lgkmcnt(1)
    ds_read_b64_tr_b16 v[160:161], v16 offset:32768
    ds_read_b64_tr_b16 v[162:163], v16 offset:34816
    ds_read_b64_tr_b16 v[164:165], v17 offset:32768
    ds_read_b64_tr_b16 v[166:167], v17 offset:34816
    ds_read_b64_tr_b16 v[168:169], v18 offset:32768
    ds_read_b64_tr_b16 v[170:171], v18 offset:34816
    ds_read_b64_tr_b16 v[172:173], v10 offset:32768
    ds_read_b64_tr_b16 v[174:175], v10 offset:34816
    s_cmp_eq_u32 s35, 0
    s_cselect_b32 s35, 0x7ffffff0, s35
    v_mov_b32 v4, 1
    v_mov_b32 v3, 0
    s_add_u32 m0, s42, 0
    s_nop 0
    buffer_load_dwordx4 v28, s[16:19], s41 offen offset:0 lds
    buffer_load_dwordx4 v29, s[16:19], s41 offen offset:1024 lds
    buffer_load_dwordx4 v30, s[16:19], s41 offen offset:2048 lds
    buffer_load_dwordx4 v31, s[16:19], s41 offen offset:3072 lds
    s_add_u32 s41, s41, 65536
    s_add_u32 m0, s42, 16384
    s_nop 0
    buffer_load_dwordx4 v28, s[16:19], s41 offen offset:0 lds
    buffer_load_dwordx4 v29, s[16:19], s41 offen offset:1024 lds
    buffer_load_dwordx4 v30, s[16:19], s41 offen offset:2048 lds
    buffer_load_dwordx4 v31, s[16:19], s41 offen offset:3072 lds
    s_add_u32 s41, s41, 65536
    s_add_u32 m0, s42, 32768
    s_nop 0
    buffer_load_dwordx4 v28, s[16:19], s41 offen offset:0 lds
    buffer_load_dwordx4 v29, s[16:19], s41 offen offset:1024 lds
    buffer_load_dwordx4 v30, s[16:19], s41 offen offset:2048 lds
    buffer_load_dwordx4 v31, s[16:19], s41 offen offset:3072 lds
    s_add_u32 s41, s41, 65536
    s_waitcnt vmcnt(12)
    s_mov_b64 exec, 1
    buffer_store_dword v4, v3, s[20:23], s35 offen sc1
    s_mov_b64 exec, -1
    buffer_load_dword v23, v21, s[20:23], s39 offen sc1
    s_add_u32 m0, s42, 49152
    s_nop 0
    buffer_load_dwordx4 v28, s[16:19], s41 offen offset:0 lds
    buffer_load_dwordx4 v29, s[16:19], s41 offen offset:1024 lds
    buffer_load_dwordx4 v30, s[16:19], s41 offen offset:2048 lds
    buffer_load_dwordx4 v31, s[16:19], s41 offen offset:3072 lds
    s_add_u32 s41, s41, 65536
    s_add_u32 m0, s42, 65536
    s_nop 0
    buffer_load_dwordx4 v28, s[16:19], s41 offen offset:0 lds
    buffer_load_dwordx4 v29, s[16:19], s41 offen offset:1024 lds
    buffer_load_dwordx4 v30, s[16:19], s41 offen offset:2048 lds
    buffer_load_dwordx4 v31, s[16:19], s41 offen offset:3072 lds
    s_add_u32 s41, s41, 65536
    s_add_u32 m0, s42, 81920
    s_nop 0
    buffer_load_dwordx4 v28, s[16:19], s41 offen offset:0 lds
    buffer_load_dwordx4 v29, s[16:19], s41 offen offset:1024 lds
    buffer_load_dwordx4 v30, s[16:19], s41 offen offset:2048 lds
    buffer_load_dwordx4 v31, s[16:19], s41 offen offset:3072 lds
    s_add_u32 s41, s41, 65536
    s_cmp_lt_u32 s2, 224
    s_cbranch_scc1 L_g2_gate
    s_cmp_lg_u32 s3, 0
    s_cbranch_scc1 L_g2_gw
    v_min_u32 v2, 27, v1
    v_lshlrev_b32 v2, 2, v2
L_g2_gp:
    s_sub_u32 s0, s0, 1
    s_cbranch_scc1 L_end
    s_sleep 12
    buffer_load_dword v3, v2, s[20:23], s39 offen sc1
    s_waitcnt vmcnt(0)
    v_cmp_eq_u32 vcc, 1, v3
    s_cbranch_vccz L_g2_gp
    v_mov_b32 v2, 155200
    v_mov_b32 v3, 1
    ds_write_b32 v2, v3
L_g2_gw:
    v_mov_b32 v2, 155200
L_lw_g2g:
    s_sub_u32 s0, s0, 1
    s_cbranch_scc1 L_end
    s_sleep 2
    ds_read_b32 v4, v2
    s_waitcnt lgkmcnt(0)
    v_cmp_gt_u32 vcc, 1, v4
    s_cbranch_vccnz L_lw_g2g
L_g2_gate:
    s_waitcnt vmcnt(12)
    v_cmp_ne_u32 vcc, 1, v23
    s_cbranch_vccz L_g2_fa_ok
L_g2_fa:
    s_sub_u32 s0, s0, 1
    s_cbranch_scc1 L_end
    s_sleep 2
    buffer_load_dword v23, v21, s[20:23], s39 offen sc1
    s_waitcnt vmcnt(0)
    v_cmp_ne_u32 vcc, 1, v23
    s_cbranch_vccnz L_g2_fa
L_g2_fa_ok:
    buffer_load_dwordx4 v[32:35], v24, s[20:23], s38 offen sc1
    buffer_load_dwordx4 v[36:39], v25, s[20:23], s38 offen sc1
    buffer_load_dwordx4 v[40:43], v26, s[20:23], s38 offen sc1
    buffer_load_dwordx4 v[44:47], v27, s[20:23], s38 offen sc1
    s_add_u32 s38, s38, 2048
    buffer_load_dwordx4 v[48:51], v24, s[20:23], s38 offen sc1
    buffer_load_dwordx4 v[52:55], v25, s[20:23], s38 offen sc1
    buffer_load_dwordx4 v[56:59], v26, s[20:23], s38 offen sc1
    buffer_load_dwordx4 v[60:63], v27, s[20:23], s38 offen sc1
    s_add_u32 s38, s38, 2048
    buffer_load_dwordx4 v[176:179], v24, s[20:23], s38 offen sc1
    buffer_load_dwordx4 v[180:183], v25, s[20:23], s38 offen sc1
    buffer_load_dwordx4 v[184:187], v26, s[20:23], s38 offen sc1
    buffer_load_dwordx4 v[188:191], v27, s[20:23], s38 offen sc1
    s_add_u32 s38, s38, 2048
    s_waitcnt lgkmcnt(0)
    s_add_u32 m0, s42, 98304
    s_nop 0
    buffer_load_dwordx4 v28, s[16:19], s41 offen offset:0 lds
    buffer_load_dwordx4 v29, s[16:19], s41 offen offset:1024 lds
    buffer_load_dwordx4 v30, s[16:19], s41 offen offset:2048 lds
    buffer_load_dwordx4 v31, s[16:19], s41 offen offset:3072 lds
    s_add_u32 s41, s41, 65536
    s_lshl_b32 s33, s3, 6
    s_mul_i32 s32, s37, 4352
    s_add_u32 s32, s32, s33
    s_lshr_b32 s33, s36, 4
    s_lshl_b32 s33, s33, 8
    s_add_u32 s32, s32, s33
    s_add_u32 s32, s32, 15204352
    v_lshrrev_b32 v2, 3, v1
    v_and_b32 v3, 7, v1
    v_bfe_u32 v4, v1, 4, 2
    v_lshlrev_b32 v4, 1, v4
    v_xor_b32 v3, v3, v4
    v_lshlrev_b32 v2, 12, v2
    v_lshl_add_u32 v8, v3, 4, v2
    v_add_u32 v9, 31744, v8
    v_and_b32 v12, 15, v1
    v_lshlrev_b32 v21, 2, v12
    v_lshlrev_b32 v12, 3, v12
    s_lshl_b32 s34, s37, 18
    s_lshl_b32 s33, s3, 16
    s_add_u32 s34, s34, s33
    s_lshl_b32 s33, s36, 7
    s_add_u32 s34, s34, s33
    s_add_u32 s34, s34, 11534336
    s_lshl_b32 s31, s36, 9
    s_lshl_b32 s33, s3, 7
    s_add_u32 s31, s31, s33
    s_add_u32 s31, s31, 10485760
    v_lshl_add_u32 v5, v1, 4, s42
    s_sub_u32 s33, s3, 1
    s_and_b32 s33, s33, 3
    s_lshl_b32 s33, s33, 12
    s_add_u32 s33, s33, 0
    v_lshl_add_u32 v13, v1, 4, s33
    s_sub_u32 s33, s3, 2
    s_and_b32 s33, s33, 3
    s_lshl_b32 s33, s33, 12
    s_add_u32 s33, s33, 16384
    v_lshl_add_u32 v19, v1, 4, s33
    s_sub_u32 s33, s3, 3
    s_and_b32 s33, s33, 3
    s_lshl_b32 s33, s33, 12
    s_add_u32 s33, s33, 32768
    v_lshl_add_u32 v20, v1, 4, s33
    v_bfe_u32 v2, v1, 2, 2
    v_and_b32 v3, 3, v1
    v_lshrrev_b32 v4, 4, v1
    v_lshl_add_u32 v6, v4, 2, v2
    v_lshlrev_b32 v6, 7, v6
    v_lshl_add_u32 v6, v3, 3, v6
    v_lshrrev_b32 v7, 1, v2
    v_and_b32 v4, 1, v4
    v_lshl_or_b32 v7, v4, 1, v7
    v_xor_b32 v7, s3, v7
    v_lshl_add_u32 v6, v7, 5, v6
    v_add_u32 v6, 131328, v6
    v_and_b32 v2, 15, v1
    v_lshlrev_b32 v2, 10, v2
    v_lshrrev_b32 v3, 4, v1
    v_lshl_add_u32 v7, v3, 4, v2
    s_lshl_b32 s1, s36, 16
    s_lshl_b32 s33, s3, 14
    s_add_u32 s1, s1, s33
    s_lshl_b32 s33, s37, 7
    s_add_u32 s1, s1, s33
    s_waitcnt vmcnt(12)
    s_waitcnt lgkmcnt(0)
    v_mfma_f32_16x16x32_bf16 v[192:195], v[64:67], v[32:35], 0
    v_mfma_f32_16x16x32_bf16 v[196:199], v[64:67], v[36:39], 0
    v_mfma_f32_16x16x32_bf16 v[200:203], v[64:67], v[40:43], 0
    v_mfma_f32_16x16x32_bf16 v[204:207], v[64:67], v[44:47], 0
    v_mfma_f32_16x16x32_bf16 v[208:211], v[68:71], v[32:35], 0
    v_mfma_f32_16x16x32_bf16 v[212:215], v[68:71], v[36:39], 0
    v_mfma_f32_16x16x32_bf16 v[216:219], v[68:71], v[40:43], 0
    v_mfma_f32_16x16x32_bf16 v[220:223], v[68:71], v[44:47], 0
    v_mfma_f32_16x16x32_bf16 v[224:227], v[72:75], v[32:35], 0
    v_mfma_f32_16x16x32_bf16 v[228:231], v[72:75], v[36:39], 0
    v_mfma_f32_16x16x32_bf16 v[232:235], v[72:75], v[40:43], 0
    v_mfma_f32_16x16x32_bf16 v[236:239], v[72:75], v[44:47], 0
    v_mfma_f32_16x16x32_bf16 v[240:243], v[76:79], v[32:35], 0
    v_mfma_f32_16x16x32_bf16 v[244:247], v[76:79], v[36:39], 0
    v_mfma_f32_16x16x32_bf16 v[248:251], v[76:79], v[40:43], 0
    v_mfma_f32_16x16x32_bf16 v[252:255], v[76:79], v[44:47], 0
    s_waitcnt vmcnt(8)
    v_mfma_f32_16x16x32_bf16 v[192:195], v[80:83], v[48:51], v[192:195]
    buffer_load_dwordx4 v[32:35], v24, s[20:23], s38 offen sc1
    v_mfma_f32_16x16x32_bf16 v[196:199], v[80:83], v[52:55], v[196:199]
    v_mfma_f32_16x16x32_bf16 v[200:203], v[80:83], v[56:59], v[200:203]
    buffer_load_dwordx4 v[36:39], v25, s[20:23], s38 offen sc1
    v_mfma_f32_16x16x32_bf16 v[204:207], v[80:83], v[60:63], v[204:207]
    v_mfma_f32_16x16x32_bf16 v[208:211], v[84:87], v[48:51], v[208:211]
    buffer_load_dwordx4 v[40:43], v26, s[20:23], s38 offen sc1
    v_mfma_f32_16x16x32_bf16 v[212:215], v[84:87], v[52:55], v[212:215]
    v_mfma_f32_16x16x32_bf16 v[216:219], v[84:87], v[56:59], v[216:219]
    buffer_load_dwordx4 v[44:47], v27, s[20:23], s38 offen sc1
    s_add_u32 s38, s38, 2048
    v_mfma_f32_16x16x32_bf16 v[220:223], v[84:87], v[60:63], v[220:223]
    v_mfma_f32_16x16x32_bf16 v[224:227], v[88:91], v[48:51], v[224:227]
    buffer_load_dwordx4 v[64:67], v24, s[20:23], s38 offen sc1
    v_mfma_f32_16x16x32_bf16 v[228:231], v[88:91], v[52:55], v[228:231]
    v_mfma_f32_16x16x32_bf16 v[232:235], v[88:91], v[56:59], v[232:235]
    buffer_load_dwordx4 v[68:71], v25, s[20:23], s38 offen sc1
    v_mfma_f32_16x16x32_bf16 v[236:239], v[88:91], v[60:63], v[236:239]
    v_mfma_f32_16x16x32_bf16 v[240:243], v[92:95], v[48:51], v[240:243]
    buffer_load_dwordx4 v[72:75], v26, s[20:23], s38 offen sc1
    v_mfma_f32_16x16x32_bf16 v[244:247], v[92:95], v[52:55], v[244:247]
    v_mfma_f32_16x16x32_bf16 v[248:251], v[92:95], v[56:59], v[248:251]
    buffer_load_dwordx4 v[76:79], v27, s[20:23], s38 offen sc1
    s_add_u32 s38, s38, 2048
    v_mfma_f32_16x16x32_bf16 v[252:255], v[92:95], v[60:63], v[252:255]
    buffer_load_dword v15, v22, s[20:23], s40 offen sc1
    s_waitcnt vmcnt(13)
    v_mfma_f32_16x16x32_bf16 v[192:195], v[96:99], v[176:179], v[192:195]
    buffer_load_dwordx4 v[48:51], v24, s[20:23], s38 offen sc1
    v_mfma_f32_16x16x32_bf16 v[196:199], v[96:99], v[180:183], v[196:199]
    v_mfma_f32_16x16x32_bf16 v[200:203], v[96:99], v[184:187], v[200:203]
    v_mfma_f32_16x16x32_bf16 v[204:207], v[96:99], v[188:191], v[204:207]
    v_mfma_f32_16x16x32_bf16 v[208:211], v[100:103], v[176:179], v[208:211]
    buffer_load_dwordx4 v[52:55], v25, s[20:23], s38 offen sc1
    v_mfma_f32_16x16x32_bf16 v[212:215], v[100:103], v[180:183], v[212:215]
    v_mfma_f32_16x16x32_bf16 v[216:219], v[100:103], v[184:187], v[216:219]
    v_mfma_f32_16x16x32_bf16 v[220:223], v[100:103], v[188:191], v[220:223]
    v_mfma_f32_16x16x32_bf16 v[224:227], v[104:107], v[176:179], v[224:227]
    buffer_load_dwordx4 v[56:59], v26, s[20:23], s38 offen sc1
    v_mfma_f32_16x16x32_bf16 v[228:231], v[104:107], v[180:183], v[228:231]
    v_mfma_f32_16x16x32_bf16 v[232:235], v[104:107], v[184:187], v[232:235]
    v_mfma_f32_16x16x32_bf16 v[236:239], v[104:107], v[188:191], v[236:239]
    v_mfma_f32_16x16x32_bf16 v[240:243], v[108:111], v[176:179], v[240:243]
    buffer_load_dwordx4 v[60:63], v27, s[20:23], s38 offen sc1
    s_add_u32 s38, s38, 2048
    v_mfma_f32_16x16x32_bf16 v[244:247], v[108:111], v[180:183], v[244:247]
    v_mfma_f32_16x16x32_bf16 v[248:251], v[108:111], v[184:187], v[248:251]
    v_mfma_f32_16x16x32_bf16 v[252:255], v[108:111], v[188:191], v[252:255]
    s_waitcnt vmcnt(9)
    v_mfma_f32_16x16x32_bf16 v[192:195], v[112:115], v[32:35], v[192:195]
    buffer_load_dwordx4 v[176:179], v24, s[20:23], s38 offen sc1
    v_mfma_f32_16x16x32_bf16 v[196:199], v[112:115], v[36:39], v[196:199]
    v_mfma_f32_16x16x32_bf16 v[200:203], v[112:115], v[40:43], v[200:203]
    v_mfma_f32_16x16x32_bf16 v[204:207], v[112:115], v[44:47], v[204:207]
    v_mfma_f32_16x16x32_bf16 v[208:211], v[116:119], v[32:35], v[208:211]
    buffer_load_dwordx4 v[180:183], v25, s[20:23], s38 offen sc1
    v_mfma_f32_16x16x32_bf16 v[212:215], v[116:119], v[36:39], v[212:215]
    v_mfma_f32_16x16x32_bf16 v[216:219], v[116:119], v[40:43], v[216:219]
    v_mfma_f32_16x16x32_bf16 v[220:223], v[116:119], v[44:47], v[220:223]
    v_mfma_f32_16x16x32_bf16 v[224:227], v[120:123], v[32:35], v[224:227]
    buffer_load_dwordx4 v[184:187], v26, s[20:23], s38 offen sc1
    v_mfma_f32_16x16x32_bf16 v[228:231], v[120:123], v[36:39], v[228:231]
    v_mfma_f32_16x16x32_bf16 v[232:235], v[120:123], v[40:43], v[232:235]
    v_mfma_f32_16x16x32_bf16 v[236:239], v[120:123], v[44:47], v[236:239]
    v_mfma_f32_16x16x32_bf16 v[240:243], v[124:127], v[32:35], v[240:243]
    buffer_load_dwordx4 v[188:191], v27, s[20:23], s38 offen sc1
    s_sub_u32 s38, s38, 11264
    v_mfma_f32_16x16x32_bf16 v[244:247], v[124:127], v[36:39], v[244:247]
    v_mfma_f32_16x16x32_bf16 v[248:251], v[124:127], v[40:43], v[248:251]
    v_mfma_f32_16x16x32_bf16 v[252:255], v[124:127], v[44:47], v[252:255]
    s_waitcnt vmcnt(9)
    s_waitcnt vmcnt(8)
    v_cmp_ne_u32 vcc, 1, v15
    s_cbranch_vccz L_g2_fb_ok
L_g2_fb:
    s_sub_u32 s0, s0, 1
    s_cbranch_scc1 L_end
    s_sleep 1
    buffer_load_dword v15, v22, s[20:23], s40 offen sc1
    s_waitcnt vmcnt(0)
    v_cmp_ne_u32 vcc, 1, v15
    s_cbranch_vccnz L_g2_fb
L_g2_fb_ok:
    v_mfma_f32_16x16x32_bf16 v[192:195], v[128:131], v[64:67], v[192:195]
    buffer_load_dwordx4 v[32:35], v24, s[20:23], s38 offen sc1
    v_mfma_f32_16x16x32_bf16 v[196:199], v[128:131], v[68:71], v[196:199]
    v_mfma_f32_16x16x32_bf16 v[200:203], v[128:131], v[72:75], v[200:203]
    v_mfma_f32_16x16x32_bf16 v[204:207], v[128:131], v[76:79], v[204:207]
    v_mfma_f32_16x16x32_bf16 v[208:211], v[132:135], v[64:67], v[208:211]
    buffer_load_dwordx4 v[36:39], v25, s[20:23], s38 offen sc1
    v_mfma_f32_16x16x32_bf16 v[212:215], v[132:135], v[68:71], v[212:215]
    v_mfma_f32_16x16x32_bf16 v[216:219], v[132:135], v[72:75], v[216:219]
    v_mfma_f32_16x16x32_bf16 v[220:223], v[132:135], v[76:79], v[220:223]
    v_mfma_f32_16x16x32_bf16 v[224:227], v[136:139], v[64:67], v[224:227]
    buffer_load_dwordx4 v[40:43], v26, s[20:23], s38 offen sc1
    v_mfma_f32_16x16x32_bf16 v[228:231], v[136:139], v[68:71], v[228:231]
    v_mfma_f32_16x16x32_bf16 v[232:235], v[136:139], v[72:75], v[232:235]
    v_mfma_f32_16x16x32_bf16 v[236:239], v[136:139], v[76:79], v[236:239]
    v_mfma_f32_16x16x32_bf16 v[240:243], v[140:143], v[64:67], v[240:243]
    buffer_load_dwordx4 v[44:47], v27, s[20:23], s38 offen sc1
    s_add_u32 s38, s38, 2048
    v_mfma_f32_16x16x32_bf16 v[244:247], v[140:143], v[68:71], v[244:247]
    v_mfma_f32_16x16x32_bf16 v[248:251], v[140:143], v[72:75], v[248:251]
    v_mfma_f32_16x16x32_bf16 v[252:255], v[140:143], v[76:79], v[252:255]
    s_waitcnt vmcnt(8)
    v_mfma_f32_16x16x32_bf16 v[192:195], v[144:147], v[48:51], v[192:195]
    buffer_load_dwordx4 v[64:67], v24, s[20:23], s38 offen sc1
    v_mfma_f32_16x16x32_bf16 v[196:199], v[144:147], v[52:55], v[196:199]
    v_mfma_f32_16x16x32_bf16 v[200:203], v[144:147], v[56:59], v[200:203]
    v_mfma_f32_16x16x32_bf16 v[204:207], v[144:147], v[60:63], v[204:207]
    v_mfma_f32_16x16x32_bf16 v[208:211], v[148:151], v[48:51], v[208:211]
    buffer_load_dwordx4 v[68:71], v25, s[20:23], s38 offen sc1
    v_mfma_f32_16x16x32_bf16 v[212:215], v[148:151], v[52:55], v[212:215]
    v_mfma_f32_16x16x32_bf16 v[216:219], v[148:151], v[56:59], v[216:219]
    v_mfma_f32_16x16x32_bf16 v[220:223], v[148:151], v[60:63], v[220:223]
    v_mfma_f32_16x16x32_bf16 v[224:227], v[152:155], v[48:51], v[224:227]
    buffer_load_dwordx4 v[72:75], v26, s[20:23], s38 offen sc1
    v_mfma_f32_16x16x32_bf16 v[228:231], v[152:155], v[52:55], v[228:231]
    v_mfma_f32_16x16x32_bf16 v[232:235], v[152:155], v[56:59], v[232:235]
    v_mfma_f32_16x16x32_bf16 v[236:239], v[152:155], v[60:63], v[236:239]
    v_mfma_f32_16x16x32_bf16 v[240:243], v[156:159], v[48:51], v[240:243]
    buffer_load_dwordx4 v[76:79], v27, s[20:23], s38 offen sc1
    s_add_u32 s38, s38, 2048
    v_mfma_f32_16x16x32_bf16 v[244:247], v[156:159], v[52:55], v[244:247]
    v_mfma_f32_16x16x32_bf16 v[248:251], v[156:159], v[56:59], v[248:251]
    v_mfma_f32_16x16x32_bf16 v[252:255], v[156:159], v[60:63], v[252:255]
    s_waitcnt vmcnt(8)
    v_mfma_f32_16x16x32_bf16 v[192:195], v[160:163], v[176:179], v[192:195]
    buffer_load_dwordx4 v[48:51], v24, s[20:23], s38 offen sc1
    v_mfma_f32_16x16x32_bf16 v[196:199], v[160:163], v[180:183], v[196:199]
    v_add_u32 v16, 4294901760, v16
    v_mfma_f32_16x16x32_bf16 v[200:203], v[160:163], v[184:187], v[200:203]
    v_add_u32 v17, 4294901760, v17
    v_mfma_f32_16x16x32_bf16 v[204:207], v[160:163], v[188:191], v[204:207]
    v_add_u32 v18, 4294901760, v18
    v_mfma_f32_16x16x32_bf16 v[208:211], v[164:167], v[176:179], v[208:211]
    v_add_u32 v10, 4294901760, v10
    buffer_load_dwordx4 v[52:55], v25, s[20:23], s38 offen sc1
    v_mfma_f32_16x16x32_bf16 v[212:215], v[164:167], v[180:183], v[212:215]
    ds_read_b64_tr_b16 v[144:145], v16 offset:0
    v_mfma_f32_16x16x32_bf16 v[216:219], v[164:167], v[184:187], v[216:219]
    ds_read_b64_tr_b16 v[146:147], v16 offset:2048
    v_mfma_f32_16x16x32_bf16 v[220:223], v[164:167], v[188:191], v[220:223]
    ds_read_b64_tr_b16 v[148:149], v17 offset:0
    v_mfma_f32_16x16x32_bf16 v[224:227], v[168:171], v[176:179], v[224:227]
    ds_read_b64_tr_b16 v[150:151], v17 offset:2048
    buffer_load_dwordx4 v[56:59], v26, s[20:23], s38 offen sc1
    v_mfma_f32_16x16x32_bf16 v[228:231], v[168:171], v[180:183], v[228:231]
    ds_read_b64_tr_b16 v[152:153], v18 offset:0
    v_mfma_f32_16x16x32_bf16 v[232:235], v[168:171], v[184:187], v[232:235]
    ds_read_b64_tr_b16 v[154:155], v18 offset:2048
    v_mfma_f32_16x16x32_bf16 v[236:239], v[168:171], v[188:191], v[236:239]
    ds_read_b64_tr_b16 v[156:157], v10 offset:0
    v_mfma_f32_16x16x32_bf16 v[240:243], v[172:175], v[176:179], v[240:243]
    ds_read_b64_tr_b16 v[158:159], v10 offset:2048
    buffer_load_dwordx4 v[60:63], v27, s[20:23], s38 offen sc1
    s_add_u32 s38, s38, 2048
    v_mfma_f32_16x16x32_bf16 v[244:247], v[172:175], v[180:183], v[244:247]
    v_mfma_f32_16x16x32_bf16 v[248:251], v[172:175], v[184:187], v[248:251]
    v_mfma_f32_16x16x32_bf16 v[252:255], v[172:175], v[188:191], v[252:255]
    s_waitcnt vmcnt(8)
    s_waitcnt lgkmcnt(0)
    v_mfma_f32_16x16x32_bf16 v[192:195], v[144:147], v[32:35], v[192:195]
    buffer_load_dwordx4 v[176:179], v24, s[20:23], s38 offen sc1
    v_mfma_f32_16x16x32_bf16 v[196:199], v[144:147], v[36:39], v[196:199]
    ds_read_b64_tr_b16 v[160:161], v16 offset:16384
    v_mfma_f32_16x16x32_bf16 v[200:203], v[144:147], v[40:43], v[200:203]
    ds_read_b64_tr_b16 v[162:163], v16 offset:18432
    v_mfma_f32_16x16x32_bf16 v[204:207], v[144:147], v[44:47], v[204:207]
    ds_read_b64_tr_b16 v[164:165], v17 offset:16384
    v_mfma_f32_16x16x32_bf16 v[208:211], v[148:151], v[32:35], v[208:211]
    ds_read_b64_tr_b16 v[166:167], v17 offset:18432
    buffer_load_dwordx4 v[180:183], v25, s[20:23], s38 offen sc1
    v_mfma_f32_16x16x32_bf16 v[212:215], v[148:151], v[36:39], v[212:215]
    ds_read_b64_tr_b16 v[168:169], v18 offset:16384
    v_mfma_f32_16x16x32_bf16 v[216:219], v[148:151], v[40:43], v[216:219]
    ds_read_b64_tr_b16 v[170:171], v18 offset:18432
    v_mfma_f32_16x16x32_bf16 v[220:223], v[148:151], v[44:47], v[220:223]
    ds_read_b64_tr_b16 v[172:173], v10 offset:16384
    v_mfma_f32_16x16x32_bf16 v[224:227], v[152:155], v[32:35], v[224:227]
    ds_read_b64_tr_b16 v[174:175], v10 offset:18432
    buffer_load_dwordx4 v[184:187], v26, s[20:23], s38 offen sc1
    v_mfma_f32_16x16x32_bf16 v[228:231], v[152:155], v[36:39], v[228:231]
    v_mfma_f32_16x16x32_bf16 v[232:235], v[152:155], v[40:43], v[232:235]
    v_mfma_f32_16x16x32_bf16 v[236:239], v[152:155], v[44:47], v[236:239]
    v_mfma_f32_16x16x32_bf16 v[240:243], v[156:159], v[32:35], v[240:243]
    buffer_load_dwordx4 v[188:191], v27, s[20:23], s38 offen sc1
    s_add_u32 s38, s38, 2048
    v_mfma_f32_16x16x32_bf16 v[244:247], v[156:159], v[36:39], v[244:247]
    v_mfma_f32_16x16x32_bf16 v[248:251], v[156:159], v[40:43], v[248:251]
    v_mfma_f32_16x16x32_bf16 v[252:255], v[156:159], v[44:47], v[252:255]
    s_waitcnt vmcnt(8)
    s_waitcnt lgkmcnt(0)
    v_mfma_f32_16x16x32_bf16 v[192:195], v[160:163], v[64:67], v[192:195]
    buffer_load_dwordx4 v[32:35], v24, s[20:23], s38 offen sc1
    v_mfma_f32_16x16x32_bf16 v[196:199], v[160:163], v[68:71], v[196:199]
    ds_read_b64_tr_b16 v[144:145], v16 offset:32768
    v_mfma_f32_16x16x32_bf16 v[200:203], v[160:163], v[72:75], v[200:203]
    ds_read_b64_tr_b16 v[146:147], v16 offset:34816
    v_mfma_f32_16x16x32_bf16 v[204:207], v[160:163], v[76:79], v[204:207]
    ds_read_b64_tr_b16 v[148:149], v17 offset:32768
    v_mfma_f32_16x16x32_bf16 v[208:211], v[164:167], v[64:67], v[208:211]
    ds_read_b64_tr_b16 v[150:151], v17 offset:34816
    buffer_load_dwordx4 v[36:39], v25, s[20:23], s38 offen sc1
    v_mfma_f32_16x16x32_bf16 v[212:215], v[164:167], v[68:71], v[212:215]
    ds_read_b64_tr_b16 v[152:153], v18 offset:32768
    v_mfma_f32_16x16x32_bf16 v[216:219], v[164:167], v[72:75], v[216:219]
    ds_read_b64_tr_b16 v[154:155], v18 offset:34816
    v_mfma_f32_16x16x32_bf16 v[220:223], v[164:167], v[76:79], v[220:223]
    ds_read_b64_tr_b16 v[156:157], v10 offset:32768
    v_mfma_f32_16x16x32_bf16 v[224:227], v[168:171], v[64:67], v[224:227]
    ds_read_b64_tr_b16 v[158:159], v10 offset:34816
    buffer_load_dwordx4 v[40:43], v26, s[20:23], s38 offen sc1
    v_mfma_f32_16x16x32_bf16 v[228:231], v[168:171], v[68:71], v[228:231]
    v_mfma_f32_16x16x32_bf16 v[232:235], v[168:171], v[72:75], v[232:235]
    v_mfma_f32_16x16x32_bf16 v[236:239], v[168:171], v[76:79], v[236:239]
    v_mfma_f32_16x16x32_bf16 v[240:243], v[172:175], v[64:67], v[240:243]
    buffer_load_dwordx4 v[44:47], v27, s[20:23], s38 offen sc1
    s_add_u32 s38, s38, 2048
    v_mfma_f32_16x16x32_bf16 v[244:247], v[172:175], v[68:71], v[244:247]
    v_mfma_f32_16x16x32_bf16 v[248:251], v[172:175], v[72:75], v[248:251]
    v_mfma_f32_16x16x32_bf16 v[252:255], v[172:175], v[76:79], v[252:255]
    buffer_load_dwordx2 v[14:15], v12, s[20:23], s31 offen sc1
    s_waitcnt vmcnt(9)
    s_waitcnt lgkmcnt(0)
    v_mfma_f32_16x16x32_bf16 v[192:195], v[144:147], v[48:51], v[192:195]
    buffer_load_dwordx4 v[64:67], v24, s[20:23], s38 offen sc1
    v_mfma_f32_16x16x32_bf16 v[196:199], v[144:147], v[52:55], v[196:199]
    ds_read_b64_tr_b16 v[160:161], v16 offset:49152
    v_mfma_f32_16x16x32_bf16 v[200:203], v[144:147], v[56:59], v[200:203]
    ds_read_b64_tr_b16 v[162:163], v16 offset:51200
    v_mfma_f32_16x16x32_bf16 v[204:207], v[144:147], v[60:63], v[204:207]
    ds_read_b64_tr_b16 v[164:165], v17 offset:49152
    v_mfma_f32_16x16x32_bf16 v[208:211], v[148:151], v[48:51], v[208:211]
    ds_read_b64_tr_b16 v[166:167], v17 offset:51200
    buffer_load_dwordx4 v[68:71], v25, s[20:23], s38 offen sc1
    v_mfma_f32_16x16x32_bf16 v[212:215], v[148:151], v[52:55], v[212:215]
    ds_read_b64_tr_b16 v[168:169], v18 offset:49152
    v_mfma_f32_16x16x32_bf16 v[216:219], v[148:151], v[56:59], v[216:219]
    ds_read_b64_tr_b16 v[170:171], v18 offset:51200
    v_mfma_f32_16x16x32_bf16 v[220:223], v[148:151], v[60:63], v[220:223]
    ds_read_b64_tr_b16 v[172:173], v10 offset:49152
    v_mfma_f32_16x16x32_bf16 v[224:227], v[152:155], v[48:51], v[224:227]
    ds_read_b64_tr_b16 v[174:175], v10 offset:51200
    buffer_load_dwordx4 v[72:75], v26, s[20:23], s38 offen sc1
    v_mfma_f32_16x16x32_bf16 v[228:231], v[152:155], v[52:55], v[228:231]
    v_mfma_f32_16x16x32_bf16 v[232:235], v[152:155], v[56:59], v[232:235]
    v_mfma_f32_16x16x32_bf16 v[236:239], v[152:155], v[60:63], v[236:239]
    v_mfma_f32_16x16x32_bf16 v[240:243], v[156:159], v[48:51], v[240:243]
    buffer_load_dwordx4 v[76:79], v27, s[20:23], s38 offen sc1
    s_add_u32 s38, s38, 2048
    v_mfma_f32_16x16x32_bf16 v[244:247], v[156:159], v[52:55], v[244:247]
    v_mfma_f32_16x16x32_bf16 v[248:251], v[156:159], v[56:59], v[248:251]
    v_mfma_f32_16x16x32_bf16 v[252:255], v[156:159], v[60:63], v[252:255]
    s_waitcnt vmcnt(9)
    s_waitcnt lgkmcnt(0)
    v_mfma_f32_16x16x32_bf16 v[192:195], v[160:163], v[176:179], v[192:195]
    buffer_load_dwordx4 v[48:51], v24, s[20:23], s38 offen sc1
    v_mfma_f32_16x16x32_bf16 v[196:199], v[160:163], v[180:183], v[196:199]
    v_add_u32 v16, 65536, v16
    v_mfma_f32_16x16x32_bf16 v[200:203], v[160:163], v[184:187], v[200:203]
    v_add_u32 v17, 65536, v17
    v_mfma_f32_16x16x32_bf16 v[204:207], v[160:163], v[188:191], v[204:207]
    v_add_u32 v18, 65536, v18
    v_mfma_f32_16x16x32_bf16 v[208:211], v[164:167], v[176:179], v[208:211]
    v_add_u32 v10, 65536, v10
    buffer_load_dwordx4 v[52:55], v25, s[20:23], s38 offen sc1
    v_mfma_f32_16x16x32_bf16 v[212:215], v[164:167], v[180:183], v[212:215]
    ds_read_b64_tr_b16 v[144:145], v16 offset:0
    v_mfma_f32_16x16x32_bf16 v[216:219], v[164:167], v[184:187], v[216:219]
    ds_read_b64_tr_b16 v[146:147], v16 offset:2048
    v_mfma_f32_16x16x32_bf16 v[220:223], v[164:167], v[188:191], v[220:223]
    ds_read_b64_tr_b16 v[148:149], v17 offset:0
    v_mfma_f32_16x16x32_bf16 v[224:227], v[168:171], v[176:179], v[224:227]
    ds_read_b64_tr_b16 v[150:151], v17 offset:2048
    buffer_load_dwordx4 v[56:59], v26, s[20:23], s38 offen sc1
    v_mfma_f32_16x16x32_bf16 v[228:231], v[168:171], v[180:183], v[228:231]
    ds_read_b64_tr_b16 v[152:153], v18 offset:0
    v_mfma_f32_16x16x32_bf16 v[232:235], v[168:171], v[184:187], v[232:235]
    ds_read_b64_tr_b16 v[154:155], v18 offset:2048
    v_mfma_f32_16x16x32_bf16 v[236:239], v[168:171], v[188:191], v[236:239]
    ds_read_b64_tr_b16 v[156:157], v10 offset:0
    v_mfma_f32_16x16x32_bf16 v[240:243], v[172:175], v[176:179], v[240:243]
    ds_read_b64_tr_b16 v[158:159], v10 offset:2048
    buffer_load_dwordx4 v[60:63], v27, s[20:23], s38 offen sc1
    s_add_u32 s38, s38, 2048
    v_mfma_f32_16x16x32_bf16 v[244:247], v[172:175], v[180:183], v[244:247]
    v_mfma_f32_16x16x32_bf16 v[248:251], v[172:175], v[184:187], v[248:251]
    v_mfma_f32_16x16x32_bf16 v[252:255], v[172:175], v[188:191], v[252:255]
    s_waitcnt vmcnt(9)
    s_waitcnt lgkmcnt(0)
    v_mfma_f32_16x16x32_bf16 v[192:195], v[144:147], v[32:35], v[192:195]
    v_mfma_f32_16x16x32_bf16 v[196:199], v[144:147], v[36:39], v[196:199]
    ds_read_b64_tr_b16 v[160:161], v16 offset:16384
    v_mfma_f32_16x16x32_bf16 v[200:203], v[144:147], v[40:43], v[200:203]
    ds_read_b64_tr_b16 v[162:163], v16 offset:18432
    v_mfma_f32_16x16x32_bf16 v[204:207], v[144:147], v[44:47], v[204:207]
    ds_read_b64_tr_b16 v[164:165], v17 offset:16384
    v_mfma_f32_16x16x32_bf16 v[208:211], v[148:151], v[32:35], v[208:211]
    ds_read_b64_tr_b16 v[166:167], v17 offset:18432
    v_mfma_f32_16x16x32_bf16 v[212:215], v[148:151], v[36:39], v[212:215]
    ds_read_b64_tr_b16 v[168:169], v18 offset:16384
    v_mfma_f32_16x16x32_bf16 v[216:219], v[148:151], v[40:43], v[216:219]
    ds_read_b64_tr_b16 v[170:171], v18 offset:18432
    v_mfma_f32_16x16x32_bf16 v[220:223], v[148:151], v[44:47], v[220:223]
    ds_read_b64_tr_b16 v[172:173], v10 offset:16384
    v_mfma_f32_16x16x32_bf16 v[224:227], v[152:155], v[32:35], v[224:227]
    ds_read_b64_tr_b16 v[174:175], v10 offset:18432
    v_mfma_f32_16x16x32_bf16 v[228:231], v[152:155], v[36:39], v[228:231]
    v_mfma_f32_16x16x32_bf16 v[232:235], v[152:155], v[40:43], v[232:235]
    v_mfma_f32_16x16x32_bf16 v[236:239], v[152:155], v[44:47], v[236:239]
    v_mfma_f32_16x16x32_bf16 v[240:243], v[156:159], v[32:35], v[240:243]
    v_mfma_f32_16x16x32_bf16 v[244:247], v[156:159], v[36:39], v[244:247]
    v_mfma_f32_16x16x32_bf16 v[248:251], v[156:159], v[40:43], v[248:251]
    v_mfma_f32_16x16x32_bf16 v[252:255], v[156:159], v[44:47], v[252:255]
    buffer_load_dword v23, v21, s[20:23], s32 offen sc1
    ds_read_b64_tr_b16 v[144:145], v16 offset:32768
    ds_read_b64_tr_b16 v[146:147], v16 offset:34816
    ds_read_b64_tr_b16 v[148:149], v17 offset:32768
    ds_read_b64_tr_b16 v[150:151], v17 offset:34816
    ds_read_b64_tr_b16 v[152:153], v18 offset:32768
    ds_read_b64_tr_b16 v[154:155], v18 offset:34816
    ds_read_b64_tr_b16 v[156:157], v10 offset:32768
    ds_read_b64_tr_b16 v[158:159], v10 offset:34816
    s_waitcnt vmcnt(1)
    s_waitcnt lgkmcnt(0)
    v_mfma_f32_16x16x32_bf16 v[196:199], v[160:163], v[68:71], v[196:199]
    v_mfma_f32_16x16x32_bf16 v[212:215], v[164:167], v[68:71], v[212:215]
    v_mfma_f32_16x16x32_bf16 v[228:231], v[168:171], v[68:71], v[228:231]
    v_mfma_f32_16x16x32_bf16 v[244:247], v[172:175], v[68:71], v[244:247]
    v_mfma_f32_16x16x32_bf16 v[196:199], v[144:147], v[52:55], v[196:199]
    v_mfma_f32_16x16x32_bf16 v[212:215], v[148:151], v[52:55], v[212:215]
    v_mfma_f32_16x16x32_bf16 v[228:231], v[152:155], v[52:55], v[228:231]
    v_mfma_f32_16x16x32_bf16 v[244:247], v[156:159], v[52:55], v[244:247]
    v_mfma_f32_16x16x32_bf16 v[200:203], v[160:163], v[72:75], v[200:203]
    v_mfma_f32_16x16x32_bf16 v[216:219], v[164:167], v[72:75], v[216:219]
    v_mfma_f32_16x16x32_bf16 v[232:235], v[168:171], v[72:75], v[232:235]
    v_mfma_f32_16x16x32_bf16 v[248:251], v[172:175], v[72:75], v[248:251]
    v_mfma_f32_16x16x32_bf16 v[200:203], v[144:147], v[56:59], v[200:203]
    ds_write_b128 v5, v[196:199] offset:0
    v_mfma_f32_16x16x32_bf16 v[216:219], v[148:151], v[56:59], v[216:219]
    ds_write_b128 v5, v[212:215] offset:1024
    v_mfma_f32_16x16x32_bf16 v[232:235], v[152:155], v[56:59], v[232:235]
    ds_write_b128 v5, v[228:231] offset:2048
    v_mfma_f32_16x16x32_bf16 v[248:251], v[156:159], v[56:59], v[248:251]
    ds_write_b128 v5, v[244:247] offset:3072
    s_waitcnt vmcnt(0)
    v_cmp_ne_u32 s[6:7], 1, v23
    s_lshl_b32 s33, s3, 11
    s_add_u32 m0, s33, 131328
    s_nop 1
    s_cmp_lg_u64 s[6:7], 0
    s_cselect_b32 s35, 0x7ffffff0, s34
    buffer_load_dwordx4 v8, s[20:23], s35 offen sc1 lds
    buffer_load_dwordx4 v9, s[20:23], s35 offen offset:1024 sc1 lds
    v_mfma_f32_16x16x32_bf16 v[204:207], v[160:163], v[76:79], v[204:207]
    v_mfma_f32_16x16x32_bf16 v[220:223], v[164:167], v[76:79], v[220:223]
    v_mfma_f32_16x16x32_bf16 v[236:239], v[168:171], v[76:79], v[236:239]
    v_mfma_f32_16x16x32_bf16 v[252:255], v[172:175], v[76:79], v[252:255]
    v_mfma_f32_16x16x32_bf16 v[204:207], v[144:147], v[60:63], v[204:207]
    ds_write_b128 v5, v[200:203] offset:16384
    v_mfma_f32_16x16x32_bf16 v[220:223], v[148:151], v[60:63], v[220:223]
    ds_write_b128 v5, v[216:219] offset:17408
    v_mfma_f32_16x16x32_bf16 v[236:239], v[152:155], v[60:63], v[236:239]
    ds_write_b128 v5, v[232:235] offset:18432
    v_mfma_f32_16x16x32_bf16 v[252:255], v[156:159], v[60:63], v[252:255]
    ds_write_b128 v5, v[248:251] offset:19456
    v_mfma_f32_16x16x32_bf16 v[192:195], v[160:163], v[64:67], v[192:195]
    v_mfma_f32_16x16x32_bf16 v[208:211], v[164:167], v[64:67], v[208:211]
    v_mfma_f32_16x16x32_bf16 v[224:227], v[168:171], v[64:67], v[224:227]
    v_mfma_f32_16x16x32_bf16 v[240:243], v[172:175], v[64:67], v[240:243]
    v_mfma_f32_16x16x32_bf16 v[192:195], v[144:147], v[48:51], v[192:195]
    ds_write_b128 v5, v[204:207] offset:32768
    v_mfma_f32_16x16x32_bf16 v[208:211], v[148:151], v[48:51], v[208:211]
    ds_write_b128 v5, v[220:223] offset:33792
    v_mfma_f32_16x16x32_bf16 v[224:227], v[152:155], v[48:51], v[224:227]
    ds_write_b128 v5, v[236:239] offset:34816
    v_mfma_f32_16x16x32_bf16 v[240:243], v[156:159], v[48:51], v[240:243]
    ds_write_b128 v5, v[252:255] offset:35840
    s_nop 3
    s_cmp_eq_u64 s[6:7], 0
    s_cbranch_scc1 L_g2_fc_ok
L_g2_fc:
    s_sub_u32 s0, s0, 1
    s_cbranch_scc1 L_end
    buffer_load_dword v23, v21, s[20:23], s32 offen sc1
    s_waitcnt vmcnt(0)
    v_cmp_ne_u32 vcc, 1, v23
    s_cbranch_vccz L_g2_fc2
    s_sleep 6
    s_branch L_g2_fc
L_g2_fc2:
    buffer_load_dwordx4 v8, s[20:23], s34 offen sc1 lds
    buffer_load_dwordx4 v9, s[20:23], s34 offen offset:1024 sc1 lds
L_g2_fc_ok:
    s_mov_b32 s31, 0xffff0000
    s_waitcnt vmcnt(0) lgkmcnt(0)
    s_barrier
    ds_read_b128 v[80:83], v13 offset:0
    ds_read_b128 v[84:87], v13 offset:1024
    ds_read_b128 v[88:91], v13 offset:2048
    ds_read_b128 v[92:95], v13 offset:3072
    ds_read_b128 v[96:99], v19 offset:0
    ds_read_b128 v[100:103], v19 offset:1024
    ds_read_b128 v[104:107], v19 offset:2048
    ds_read_b128 v[108:111], v19 offset:3072
    ds_read_b128 v[112:115], v20 offset:0
    ds_read_b128 v[116:119], v20 offset:1024
    ds_read_b128 v[120:123], v20 offset:2048
    ds_read_b128 v[124:127], v20 offset:3072
    ds_read_b64_tr_b16 v[32:33], v6 offset:0
    ds_read_b64_tr_b16 v[34:35], v6 offset:2048
    ds_read_b64_tr_b16 v[36:37], v6 offset:4096
    ds_read_b64_tr_b16 v[38:39], v6 offset:6144
    s_waitcnt lgkmcnt(12)
    v_pk_add_f32 v[64:65], v[192:193], v[80:81]
    v_pk_add_f32 v[66:67], v[194:195], v[82:83]
    v_pk_add_f32 v[68:69], v[208:209], v[84:85]
    v_pk_add_f32 v[70:71], v[210:211], v[86:87]
    v_pk_add_f32 v[72:73], v[224:225], v[88:89]
    v_pk_add_f32 v[74:75], v[226:227], v[90:91]
    v_pk_add_f32 v[76:77], v[240:241], v[92:93]
    v_pk_add_f32 v[78:79], v[242:243], v[94:95]
    s_waitcnt lgkmcnt(4)
    v_pk_add_f32 v[96:97], v[96:97], v[112:113]
    v_pk_add_f32 v[98:99], v[98:99], v[114:115]
    v_pk_add_f32 v[100:101], v[100:101], v[116:117]
    v_pk_add_f32 v[102:103], v[102:103], v[118:119]
    v_pk_add_f32 v[104:105], v[104:105], v[120:121]
    v_pk_add_f32 v[106:107], v[106:107], v[122:123]
    v_pk_add_f32 v[108:109], v[108:109], v[124:125]
    v_pk_add_f32 v[110:111], v[110:111], v[126:127]
    v_pk_add_f32 v[64:65], v[64:65], v[96:97]
    v_pk_add_f32 v[66:67], v[66:67], v[98:99]
    v_pk_add_f32 v[68:69], v[68:69], v[100:101]
    v_pk_add_f32 v[70:71], v[70:71], v[102:103]
    v_pk_add_f32 v[72:73], v[72:73], v[104:105]
    v_pk_add_f32 v[74:75], v[74:75], v[106:107]
    v_pk_add_f32 v[76:77], v[76:77], v[108:109]
    v_pk_add_f32 v[78:79], v[78:79], v[110:111]
    v_pk_mul_f32 v[64:65], v[64:65], v[14:15] op_sel:[0,1] op_sel_hi:[1,1]
    v_pk_mul_f32 v[66:67], v[66:67], v[14:15] op_sel:[0,1] op_sel_hi:[1,1]
    v_pk_mul_f32 v[68:69], v[68:69], v[14:15] op_sel:[0,1] op_sel_hi:[1,1]
    v_pk_mul_f32 v[70:71], v[70:71], v[14:15] op_sel:[0,1] op_sel_hi:[1,1]
    v_pk_mul_f32 v[72:73], v[72:73], v[14:15] op_sel:[0,1] op_sel_hi:[1,1]
    v_pk_mul_f32 v[74:75], v[74:75], v[14:15] op_sel:[0,1] op_sel_hi:[1,1]
    v_pk_mul_f32 v[76:77], v[76:77], v[14:15] op_sel:[0,1] op_sel_hi:[1,1]
    v_pk_mul_f32 v[78:79], v[78:79], v[14:15] op_sel:[0,1] op_sel_hi:[1,1]
    s_waitcnt lgkmcnt(0)
    v_lshlrev_b32 v40, 16, v32
    v_and_b32 v41, s31, v32
    v_fmac_f32 v64, v40, v14
    v_fmac_f32 v65, v41, v14
    v_lshlrev_b32 v40, 16, v33
    v_and_b32 v41, s31, v33
    v_fmac_f32 v66, v40, v14
    v_fmac_f32 v67, v41, v14
    v_lshlrev_b32 v40, 16, v34
    v_and_b32 v41, s31, v34
    v_fmac_f32 v68, v40, v14
    v_fmac_f32 v69, v41, v14
    v_lshlrev_b32 v40, 16, v35
    v_and_b32 v41, s31, v35
    v_fmac_f32 v70, v40, v14
    v_fmac_f32 v71, v41, v14
    v_lshlrev_b32 v40, 16, v36
    v_and_b32 v41, s31, v36
    v_fmac_f32 v72, v40, v14
    v_fmac_f32 v73, v41, v14
    v_lshlrev_b32 v40, 16, v37
    v_and_b32 v41, s31, v37
    v_fmac_f32 v74, v40, v14
    v_fmac_f32 v75, v41, v14
    v_lshlrev_b32 v40, 16, v38
    v_and_b32 v41, s31, v38
    v_fmac_f32 v76, v40, v14
    v_fmac_f32 v77, v41, v14
    v_lshlrev_b32 v40, 16, v39
    v_and_b32 v41, s31, v39
    v_fmac_f32 v78, v40, v14
    v_fmac_f32 v79, v41, v14
    v_cvt_pk_bf16_f32 v44, v64, v65
    v_cvt_pk_bf16_f32 v45, v66, v67
    v_cvt_pk_bf16_f32 v46, v68, v69
    v_cvt_pk_bf16_f32 v47, v70, v71
    s_nop 1
    v_permlane32_swap_b32 v44, v46
    v_permlane32_swap_b32 v45, v47
    s_nop 1
    v_permlane16_swap_b32 v44, v46
    v_permlane16_swap_b32 v45, v47
    buffer_store_dwordx4 v[44:47], v7, s[24:27], s1 offen offset:0
    v_cvt_pk_bf16_f32 v48, v72, v73
    v_cvt_pk_bf16_f32 v49, v74, v75
    v_cvt_pk_bf16_f32 v50, v76, v77
    v_cvt_pk_bf16_f32 v51, v78, v79
    s_nop 1
    v_permlane32_swap_b32 v48, v50
    v_permlane32_swap_b32 v49, v51
    s_nop 1
    v_permlane16_swap_b32 v48, v50
    v_permlane16_swap_b32 v49, v51
    buffer_store_dwordx4 v[48:51], v7, s[24:27], s1 offen offset:64
    s_endpgm
L_tr_post:
    s_sub_u32 s24, s2, 224
    s_lshl_b32 s25, s24, 2
    s_add_u32 s25, s25, s3
    s_lshl_b32 s28, s25, 14
    v_lshlrev_b32 v9, 4, v1
    buffer_load_dwordx4 v[128:131], v9, s[8:11], s28 offen offset:0
    buffer_load_dwordx4 v[132:135], v9, s[8:11], s28 offen offset:1024
    buffer_load_dwordx4 v[136:139], v9, s[8:11], s28 offen offset:2048
    buffer_load_dwordx4 v[140:143], v9, s[8:11], s28 offen offset:3072
    s_add_u32 s28, s28, 4096
    buffer_load_dwordx4 v[144:147], v9, s[8:11], s28 offen offset:0
    buffer_load_dwordx4 v[148:151], v9, s[8:11], s28 offen offset:1024
    buffer_load_dwordx4 v[152:155], v9, s[8:11], s28 offen offset:2048
    buffer_load_dwordx4 v[156:159], v9, s[8:11], s28 offen offset:3072
    s_add_u32 s28, s28, 4096
    buffer_load_dwordx4 v[160:163], v9, s[8:11], s28 offen offset:0
    buffer_load_dwordx4 v[164:167], v9, s[8:11], s28 offen offset:1024
    buffer_load_dwordx4 v[168:171], v9, s[8:11], s28 offen offset:2048
    buffer_load_dwordx4 v[172:175], v9, s[8:11], s28 offen offset:3072
    s_add_u32 s28, s28, 4096
    buffer_load_dwordx4 v[176:179], v9, s[8:11], s28 offen offset:0
    buffer_load_dwordx4 v[180:183], v9, s[8:11], s28 offen offset:1024
    buffer_load_dwordx4 v[184:187], v9, s[8:11], s28 offen offset:2048
    buffer_load_dwordx4 v[188:191], v9, s[8:11], s28 offen offset:3072
    s_add_u32 s28, s28, 4096
    global_load_dwordx4 v[192:195], v9, s[62:63]
    s_mov_b32 s6, s24
    s_mov_b32 s7, s25
    s_mov_b32 s24, s64
    s_and_b32 s25, s65, 0xffff
    s_mov_b32 s26, 2097152
    s_mov_b32 s27, 0x00020000
    v_lshrrev_b32 v5, 4, v1
    s_mov_b32 s31, 0xffff0000
    s_waitcnt vmcnt(0)
    v_lshlrev_b32 v20, 16, v192
    v_and_b32 v21, s31, v192
    v_lshlrev_b32 v22, 16, v193
    v_and_b32 v23, s31, v193
    v_lshlrev_b32 v24, 16, v194
    v_and_b32 v25, s31, v194
    v_lshlrev_b32 v26, 16, v195
    v_and_b32 v27, s31, v195
    v_lshlrev_b32 v32, 16, v128
    v_and_b32 v33, s31, v128
    v_lshlrev_b32 v34, 16, v129
    v_and_b32 v35, s31, v129
    v_lshlrev_b32 v36, 16, v130
    v_and_b32 v37, s31, v130
    v_lshlrev_b32 v38, 16, v131
    v_and_b32 v39, s31, v131
    v_pk_mul_f32 v[32:33], v[32:33], v[20:21]
    v_pk_mul_f32 v[34:35], v[34:35], v[22:23]
    v_pk_mul_f32 v[36:37], v[36:37], v[24:25]
    v_pk_mul_f32 v[38:39], v[38:39], v[26:27]
    v_cvt_pk_bf16_f32 v32, v32, v33
    v_cvt_pk_bf16_f32 v34, v34, v35
    v_cvt_pk_bf16_f32 v36, v36, v37
    v_cvt_pk_bf16_f32 v38, v38, v39
    v_and_b32 v33, s31, v32
    v_lshlrev_b32 v32, 16, v32
    v_and_b32 v35, s31, v34
    v_lshlrev_b32 v34, 16, v34
    v_and_b32 v37, s31, v36
    v_lshlrev_b32 v36, 16, v36
    v_and_b32 v39, s31, v38
    v_lshlrev_b32 v38, 16, v38
    v_pk_add_f32 v[32:33], v[32:33], v[34:35]
    v_pk_add_f32 v[36:37], v[36:37], v[38:39]
    v_pk_add_f32 v[32:33], v[32:33], v[36:37]
    v_add_f32 v64, v32, v33
    v_lshlrev_b32 v40, 16, v132
    v_and_b32 v41, s31, v132
    v_lshlrev_b32 v42, 16, v133
    v_and_b32 v43, s31, v133
    v_lshlrev_b32 v44, 16, v134
    v_and_b32 v45, s31, v134
    v_lshlrev_b32 v46, 16, v135
    v_and_b32 v47, s31, v135
    v_pk_mul_f32 v[40:41], v[40:41], v[20:21]
    v_pk_mul_f32 v[42:43], v[42:43], v[22:23]
    v_pk_mul_f32 v[44:45], v[44:45], v[24:25]
    v_pk_mul_f32 v[46:47], v[46:47], v[26:27]
    v_cvt_pk_bf16_f32 v40, v40, v41
    v_cvt_pk_bf16_f32 v42, v42, v43
    v_cvt_pk_bf16_f32 v44, v44, v45
    v_cvt_pk_bf16_f32 v46, v46, v47
    v_and_b32 v41, s31, v40
    v_lshlrev_b32 v40, 16, v40
    v_and_b32 v43, s31, v42
    v_lshlrev_b32 v42, 16, v42
    v_and_b32 v45, s31, v44
    v_lshlrev_b32 v44, 16, v44
    v_and_b32 v47, s31, v46
    v_lshlrev_b32 v46, 16, v46
    v_pk_add_f32 v[40:41], v[40:41], v[42:43]
    v_pk_add_f32 v[44:45], v[44:45], v[46:47]
    v_pk_add_f32 v[40:41], v[40:41], v[44:45]
    v_add_f32 v65, v40, v41
    v_lshlrev_b32 v32, 16, v136
    v_and_b32 v33, s31, v136
    v_lshlrev_b32 v34, 16, v137
    v_and_b32 v35, s31, v137
    v_lshlrev_b32 v36, 16, v138
    v_and_b32 v37, s31, v138
    v_lshlrev_b32 v38, 16, v139
    v_and_b32 v39, s31, v139
    v_pk_mul_f32 v[32:33], v[32:33], v[20:21]
    v_pk_mul_f32 v[34:35], v[34:35], v[22:23]
    v_pk_mul_f32 v[36:37], v[36:37], v[24:25]
    v_pk_mul_f32 v[38:39], v[38:39], v[26:27]
    v_cvt_pk_bf16_f32 v32, v32, v33
    v_cvt_pk_bf16_f32 v34, v34, v35
    v_cvt_pk_bf16_f32 v36, v36, v37
    v_cvt_pk_bf16_f32 v38, v38, v39
    v_and_b32 v33, s31, v32
    v_lshlrev_b32 v32, 16, v32
    v_and_b32 v35, s31, v34
    v_lshlrev_b32 v34, 16, v34
    v_and_b32 v37, s31, v36
    v_lshlrev_b32 v36, 16, v36
    v_and_b32 v39, s31, v38
    v_lshlrev_b32 v38, 16, v38
    v_pk_add_f32 v[32:33], v[32:33], v[34:35]
    v_pk_add_f32 v[36:37], v[36:37], v[38:39]
    v_pk_add_f32 v[32:33], v[32:33], v[36:37]
    v_add_f32 v66, v32, v33
    v_lshlrev_b32 v40, 16, v140
    v_and_b32 v41, s31, v140
    v_lshlrev_b32 v42, 16, v141
    v_and_b32 v43, s31, v141
    v_lshlrev_b32 v44, 16, v142
    v_and_b32 v45, s31, v142
    v_lshlrev_b32 v46, 16, v143
    v_and_b32 v47, s31, v143
    v_pk_mul_f32 v[40:41], v[40:41], v[20:21]
    v_pk_mul_f32 v[42:43], v[42:43], v[22:23]
    v_pk_mul_f32 v[44:45], v[44:45], v[24:25]
    v_pk_mul_f32 v[46:47], v[46:47], v[26:27]
    v_cvt_pk_bf16_f32 v40, v40, v41
    v_cvt_pk_bf16_f32 v42, v42, v43
    v_cvt_pk_bf16_f32 v44, v44, v45
    v_cvt_pk_bf16_f32 v46, v46, v47
    v_and_b32 v41, s31, v40
    v_lshlrev_b32 v40, 16, v40
    v_and_b32 v43, s31, v42
    v_lshlrev_b32 v42, 16, v42
    v_and_b32 v45, s31, v44
    v_lshlrev_b32 v44, 16, v44
    v_and_b32 v47, s31, v46
    v_lshlrev_b32 v46, 16, v46
    v_pk_add_f32 v[40:41], v[40:41], v[42:43]
    v_pk_add_f32 v[44:45], v[44:45], v[46:47]
    v_pk_add_f32 v[40:41], v[40:41], v[44:45]
    v_add_f32 v67, v40, v41
    v_lshlrev_b32 v32, 16, v144
    v_and_b32 v33, s31, v144
    v_lshlrev_b32 v34, 16, v145
    v_and_b32 v35, s31, v145
    v_lshlrev_b32 v36, 16, v146
    v_and_b32 v37, s31, v146
    v_lshlrev_b32 v38, 16, v147
    v_and_b32 v39, s31, v147
    v_pk_mul_f32 v[32:33], v[32:33], v[20:21]
    v_pk_mul_f32 v[34:35], v[34:35], v[22:23]
    v_pk_mul_f32 v[36:37], v[36:37], v[24:25]
    v_pk_mul_f32 v[38:39], v[38:39], v[26:27]
    v_cvt_pk_bf16_f32 v32, v32, v33
    v_cvt_pk_bf16_f32 v34, v34, v35
    v_cvt_pk_bf16_f32 v36, v36, v37
    v_cvt_pk_bf16_f32 v38, v38, v39
    v_and_b32 v33, s31, v32
    v_lshlrev_b32 v32, 16, v32
    v_and_b32 v35, s31, v34
    v_lshlrev_b32 v34, 16, v34
    v_and_b32 v37, s31, v36
    v_lshlrev_b32 v36, 16, v36
    v_and_b32 v39, s31, v38
    v_lshlrev_b32 v38, 16, v38
    v_pk_add_f32 v[32:33], v[32:33], v[34:35]
    v_pk_add_f32 v[36:37], v[36:37], v[38:39]
    v_pk_add_f32 v[32:33], v[32:33], v[36:37]
    v_add_f32 v68, v32, v33
    v_lshlrev_b32 v40, 16, v148
    v_and_b32 v41, s31, v148
    v_lshlrev_b32 v42, 16, v149
    v_and_b32 v43, s31, v149
    v_lshlrev_b32 v44, 16, v150
    v_and_b32 v45, s31, v150
    v_lshlrev_b32 v46, 16, v151
    v_and_b32 v47, s31, v151
    v_pk_mul_f32 v[40:41], v[40:41], v[20:21]
    v_pk_mul_f32 v[42:43], v[42:43], v[22:23]
    v_pk_mul_f32 v[44:45], v[44:45], v[24:25]
    v_pk_mul_f32 v[46:47], v[46:47], v[26:27]
    v_cvt_pk_bf16_f32 v40, v40, v41
    v_cvt_pk_bf16_f32 v42, v42, v43
    v_cvt_pk_bf16_f32 v44, v44, v45
    v_cvt_pk_bf16_f32 v46, v46, v47
    v_and_b32 v41, s31, v40
    v_lshlrev_b32 v40, 16, v40
    v_and_b32 v43, s31, v42
    v_lshlrev_b32 v42, 16, v42
    v_and_b32 v45, s31, v44
    v_lshlrev_b32 v44, 16, v44
    v_and_b32 v47, s31, v46
    v_lshlrev_b32 v46, 16, v46
    v_pk_add_f32 v[40:41], v[40:41], v[42:43]
    v_pk_add_f32 v[44:45], v[44:45], v[46:47]
    v_pk_add_f32 v[40:41], v[40:41], v[44:45]
    v_add_f32 v69, v40, v41
    v_lshlrev_b32 v32, 16, v152
    v_and_b32 v33, s31, v152
    v_lshlrev_b32 v34, 16, v153
    v_and_b32 v35, s31, v153
    v_lshlrev_b32 v36, 16, v154
    v_and_b32 v37, s31, v154
    v_lshlrev_b32 v38, 16, v155
    v_and_b32 v39, s31, v155
    v_pk_mul_f32 v[32:33], v[32:33], v[20:21]
    v_pk_mul_f32 v[34:35], v[34:35], v[22:23]
    v_pk_mul_f32 v[36:37], v[36:37], v[24:25]
    v_pk_mul_f32 v[38:39], v[38:39], v[26:27]
    v_cvt_pk_bf16_f32 v32, v32, v33
    v_cvt_pk_bf16_f32 v34, v34, v35
    v_cvt_pk_bf16_f32 v36, v36, v37
    v_cvt_pk_bf16_f32 v38, v38, v39
    v_and_b32 v33, s31, v32
    v_lshlrev_b32 v32, 16, v32
    v_and_b32 v35, s31, v34
    v_lshlrev_b32 v34, 16, v34
    v_and_b32 v37, s31, v36
    v_lshlrev_b32 v36, 16, v36
    v_and_b32 v39, s31, v38
    v_lshlrev_b32 v38, 16, v38
    v_pk_add_f32 v[32:33], v[32:33], v[34:35]
    v_pk_add_f32 v[36:37], v[36:37], v[38:39]
    v_pk_add_f32 v[32:33], v[32:33], v[36:37]
    v_add_f32 v70, v32, v33
    v_lshlrev_b32 v40, 16, v156
    v_and_b32 v41, s31, v156
    v_lshlrev_b32 v42, 16, v157
    v_and_b32 v43, s31, v157
    v_lshlrev_b32 v44, 16, v158
    v_and_b32 v45, s31, v158
    v_lshlrev_b32 v46, 16, v159
    v_and_b32 v47, s31, v159
    v_pk_mul_f32 v[40:41], v[40:41], v[20:21]
    v_pk_mul_f32 v[42:43], v[42:43], v[22:23]
    v_pk_mul_f32 v[44:45], v[44:45], v[24:25]
    v_pk_mul_f32 v[46:47], v[46:47], v[26:27]
    v_cvt_pk_bf16_f32 v40, v40, v41
    v_cvt_pk_bf16_f32 v42, v42, v43
    v_cvt_pk_bf16_f32 v44, v44, v45
    v_cvt_pk_bf16_f32 v46, v46, v47
    v_and_b32 v41, s31, v40
    v_lshlrev_b32 v40, 16, v40
    v_and_b32 v43, s31, v42
    v_lshlrev_b32 v42, 16, v42
    v_and_b32 v45, s31, v44
    v_lshlrev_b32 v44, 16, v44
    v_and_b32 v47, s31, v46
    v_lshlrev_b32 v46, 16, v46
    v_pk_add_f32 v[40:41], v[40:41], v[42:43]
    v_pk_add_f32 v[44:45], v[44:45], v[46:47]
    v_pk_add_f32 v[40:41], v[40:41], v[44:45]
    v_add_f32 v71, v40, v41
    v_lshlrev_b32 v32, 16, v160
    v_and_b32 v33, s31, v160
    v_lshlrev_b32 v34, 16, v161
    v_and_b32 v35, s31, v161
    v_lshlrev_b32 v36, 16, v162
    v_and_b32 v37, s31, v162
    v_lshlrev_b32 v38, 16, v163
    v_and_b32 v39, s31, v163
    v_pk_mul_f32 v[32:33], v[32:33], v[20:21]
    v_pk_mul_f32 v[34:35], v[34:35], v[22:23]
    v_pk_mul_f32 v[36:37], v[36:37], v[24:25]
    v_pk_mul_f32 v[38:39], v[38:39], v[26:27]
    v_cvt_pk_bf16_f32 v32, v32, v33
    v_cvt_pk_bf16_f32 v34, v34, v35
    v_cvt_pk_bf16_f32 v36, v36, v37
    v_cvt_pk_bf16_f32 v38, v38, v39
    v_and_b32 v33, s31, v32
    v_lshlrev_b32 v32, 16, v32
    v_and_b32 v35, s31, v34
    v_lshlrev_b32 v34, 16, v34
    v_and_b32 v37, s31, v36
    v_lshlrev_b32 v36, 16, v36
    v_and_b32 v39, s31, v38
    v_lshlrev_b32 v38, 16, v38
    v_pk_add_f32 v[32:33], v[32:33], v[34:35]
    v_pk_add_f32 v[36:37], v[36:37], v[38:39]
    v_pk_add_f32 v[32:33], v[32:33], v[36:37]
    v_add_f32 v72, v32, v33
    v_lshlrev_b32 v40, 16, v164
    v_and_b32 v41, s31, v164
    v_lshlrev_b32 v42, 16, v165
    v_and_b32 v43, s31, v165
    v_lshlrev_b32 v44, 16, v166
    v_and_b32 v45, s31, v166
    v_lshlrev_b32 v46, 16, v167
    v_and_b32 v47, s31, v167
    v_pk_mul_f32 v[40:41], v[40:41], v[20:21]
    v_pk_mul_f32 v[42:43], v[42:43], v[22:23]
    v_pk_mul_f32 v[44:45], v[44:45], v[24:25]
    v_pk_mul_f32 v[46:47], v[46:47], v[26:27]
    v_cvt_pk_bf16_f32 v40, v40, v41
    v_cvt_pk_bf16_f32 v42, v42, v43
    v_cvt_pk_bf16_f32 v44, v44, v45
    v_cvt_pk_bf16_f32 v46, v46, v47
    v_and_b32 v41, s31, v40
    v_lshlrev_b32 v40, 16, v40
    v_and_b32 v43, s31, v42
    v_lshlrev_b32 v42, 16, v42
    v_and_b32 v45, s31, v44
    v_lshlrev_b32 v44, 16, v44
    v_and_b32 v47, s31, v46
    v_lshlrev_b32 v46, 16, v46
    v_pk_add_f32 v[40:41], v[40:41], v[42:43]
    v_pk_add_f32 v[44:45], v[44:45], v[46:47]
    v_pk_add_f32 v[40:41], v[40:41], v[44:45]
    v_add_f32 v73, v40, v41
    v_lshlrev_b32 v32, 16, v168
    v_and_b32 v33, s31, v168
    v_lshlrev_b32 v34, 16, v169
    v_and_b32 v35, s31, v169
    v_lshlrev_b32 v36, 16, v170
    v_and_b32 v37, s31, v170
    v_lshlrev_b32 v38, 16, v171
    v_and_b32 v39, s31, v171
    v_pk_mul_f32 v[32:33], v[32:33], v[20:21]
    v_pk_mul_f32 v[34:35], v[34:35], v[22:23]
    v_pk_mul_f32 v[36:37], v[36:37], v[24:25]
    v_pk_mul_f32 v[38:39], v[38:39], v[26:27]
    v_cvt_pk_bf16_f32 v32, v32, v33
    v_cvt_pk_bf16_f32 v34, v34, v35
    v_cvt_pk_bf16_f32 v36, v36, v37
    v_cvt_pk_bf16_f32 v38, v38, v39
    v_and_b32 v33, s31, v32
    v_lshlrev_b32 v32, 16, v32
    v_and_b32 v35, s31, v34
    v_lshlrev_b32 v34, 16, v34
    v_and_b32 v37, s31, v36
    v_lshlrev_b32 v36, 16, v36
    v_and_b32 v39, s31, v38
    v_lshlrev_b32 v38, 16, v38
    v_pk_add_f32 v[32:33], v[32:33], v[34:35]
    v_pk_add_f32 v[36:37], v[36:37], v[38:39]
    v_pk_add_f32 v[32:33], v[32:33], v[36:37]
    v_add_f32 v74, v32, v33
    v_lshlrev_b32 v40, 16, v172
    v_and_b32 v41, s31, v172
    v_lshlrev_b32 v42, 16, v173
    v_and_b32 v43, s31, v173
    v_lshlrev_b32 v44, 16, v174
    v_and_b32 v45, s31, v174
    v_lshlrev_b32 v46, 16, v175
    v_and_b32 v47, s31, v175
    v_pk_mul_f32 v[40:41], v[40:41], v[20:21]
    v_pk_mul_f32 v[42:43], v[42:43], v[22:23]
    v_pk_mul_f32 v[44:45], v[44:45], v[24:25]
    v_pk_mul_f32 v[46:47], v[46:47], v[26:27]
    v_cvt_pk_bf16_f32 v40, v40, v41
    v_cvt_pk_bf16_f32 v42, v42, v43
    v_cvt_pk_bf16_f32 v44, v44, v45
    v_cvt_pk_bf16_f32 v46, v46, v47
    v_and_b32 v41, s31, v40
    v_lshlrev_b32 v40, 16, v40
    v_and_b32 v43, s31, v42
    v_lshlrev_b32 v42, 16, v42
    v_and_b32 v45, s31, v44
    v_lshlrev_b32 v44, 16, v44
    v_and_b32 v47, s31, v46
    v_lshlrev_b32 v46, 16, v46
    v_pk_add_f32 v[40:41], v[40:41], v[42:43]
    v_pk_add_f32 v[44:45], v[44:45], v[46:47]
    v_pk_add_f32 v[40:41], v[40:41], v[44:45]
    v_add_f32 v75, v40, v41
    v_lshlrev_b32 v32, 16, v176
    v_and_b32 v33, s31, v176
    v_lshlrev_b32 v34, 16, v177
    v_and_b32 v35, s31, v177
    v_lshlrev_b32 v36, 16, v178
    v_and_b32 v37, s31, v178
    v_lshlrev_b32 v38, 16, v179
    v_and_b32 v39, s31, v179
    v_pk_mul_f32 v[32:33], v[32:33], v[20:21]
    v_pk_mul_f32 v[34:35], v[34:35], v[22:23]
    v_pk_mul_f32 v[36:37], v[36:37], v[24:25]
    v_pk_mul_f32 v[38:39], v[38:39], v[26:27]
    v_cvt_pk_bf16_f32 v32, v32, v33
    v_cvt_pk_bf16_f32 v34, v34, v35
    v_cvt_pk_bf16_f32 v36, v36, v37
    v_cvt_pk_bf16_f32 v38, v38, v39
    v_and_b32 v33, s31, v32
    v_lshlrev_b32 v32, 16, v32
    v_and_b32 v35, s31, v34
    v_lshlrev_b32 v34, 16, v34
    v_and_b32 v37, s31, v36
    v_lshlrev_b32 v36, 16, v36
    v_and_b32 v39, s31, v38
    v_lshlrev_b32 v38, 16, v38
    v_pk_add_f32 v[32:33], v[32:33], v[34:35]
    v_pk_add_f32 v[36:37], v[36:37], v[38:39]
    v_pk_add_f32 v[32:33], v[32:33], v[36:37]
    v_add_f32 v76, v32, v33
    v_lshlrev_b32 v40, 16, v180
    v_and_b32 v41, s31, v180
    v_lshlrev_b32 v42, 16, v181
    v_and_b32 v43, s31, v181
    v_lshlrev_b32 v44, 16, v182
    v_and_b32 v45, s31, v182
    v_lshlrev_b32 v46, 16, v183
    v_and_b32 v47, s31, v183
    v_pk_mul_f32 v[40:41], v[40:41], v[20:21]
    v_pk_mul_f32 v[42:43], v[42:43], v[22:23]
    v_pk_mul_f32 v[44:45], v[44:45], v[24:25]
    v_pk_mul_f32 v[46:47], v[46:47], v[26:27]
    v_cvt_pk_bf16_f32 v40, v40, v41
    v_cvt_pk_bf16_f32 v42, v42, v43
    v_cvt_pk_bf16_f32 v44, v44, v45
    v_cvt_pk_bf16_f32 v46, v46, v47
    v_and_b32 v41, s31, v40
    v_lshlrev_b32 v40, 16, v40
    v_and_b32 v43, s31, v42
    v_lshlrev_b32 v42, 16, v42
    v_and_b32 v45, s31, v44
    v_lshlrev_b32 v44, 16, v44
    v_and_b32 v47, s31, v46
    v_lshlrev_b32 v46, 16, v46
    v_pk_add_f32 v[40:41], v[40:41], v[42:43]
    v_pk_add_f32 v[44:45], v[44:45], v[46:47]
    v_pk_add_f32 v[40:41], v[40:41], v[44:45]
    v_add_f32 v77, v40, v41
    v_lshlrev_b32 v32, 16, v184
    v_and_b32 v33, s31, v184
    v_lshlrev_b32 v34, 16, v185
    v_and_b32 v35, s31, v185
    v_lshlrev_b32 v36, 16, v186
    v_and_b32 v37, s31, v186
    v_lshlrev_b32 v38, 16, v187
    v_and_b32 v39, s31, v187
    v_pk_mul_f32 v[32:33], v[32:33], v[20:21]
    v_pk_mul_f32 v[34:35], v[34:35], v[22:23]
    v_pk_mul_f32 v[36:37], v[36:37], v[24:25]
    v_pk_mul_f32 v[38:39], v[38:39], v[26:27]
    v_cvt_pk_bf16_f32 v32, v32, v33
    v_cvt_pk_bf16_f32 v34, v34, v35
    v_cvt_pk_bf16_f32 v36, v36, v37
    v_cvt_pk_bf16_f32 v38, v38, v39
    v_and_b32 v33, s31, v32
    v_lshlrev_b32 v32, 16, v32
    v_and_b32 v35, s31, v34
    v_lshlrev_b32 v34, 16, v34
    v_and_b32 v37, s31, v36
    v_lshlrev_b32 v36, 16, v36
    v_and_b32 v39, s31, v38
    v_lshlrev_b32 v38, 16, v38
    v_pk_add_f32 v[32:33], v[32:33], v[34:35]
    v_pk_add_f32 v[36:37], v[36:37], v[38:39]
    v_pk_add_f32 v[32:33], v[32:33], v[36:37]
    v_add_f32 v78, v32, v33
    v_lshlrev_b32 v40, 16, v188
    v_and_b32 v41, s31, v188
    v_lshlrev_b32 v42, 16, v189
    v_and_b32 v43, s31, v189
    v_lshlrev_b32 v44, 16, v190
    v_and_b32 v45, s31, v190
    v_lshlrev_b32 v46, 16, v191
    v_and_b32 v47, s31, v191
    v_pk_mul_f32 v[40:41], v[40:41], v[20:21]
    v_pk_mul_f32 v[42:43], v[42:43], v[22:23]
    v_pk_mul_f32 v[44:45], v[44:45], v[24:25]
    v_pk_mul_f32 v[46:47], v[46:47], v[26:27]
    v_cvt_pk_bf16_f32 v40, v40, v41
    v_cvt_pk_bf16_f32 v42, v42, v43
    v_cvt_pk_bf16_f32 v44, v44, v45
    v_cvt_pk_bf16_f32 v46, v46, v47
    v_and_b32 v41, s31, v40
    v_lshlrev_b32 v40, 16, v40
    v_and_b32 v43, s31, v42
    v_lshlrev_b32 v42, 16, v42
    v_and_b32 v45, s31, v44
    v_lshlrev_b32 v44, 16, v44
    v_and_b32 v47, s31, v46
    v_lshlrev_b32 v46, 16, v46
    v_pk_add_f32 v[40:41], v[40:41], v[42:43]
    v_pk_add_f32 v[44:45], v[44:45], v[46:47]
    v_pk_add_f32 v[40:41], v[40:41], v[44:45]
    v_add_f32 v79, v40, v41
    s_nop 1
    v_permlane32_swap_b32 v64, v72
    v_permlane32_swap_b32 v65, v73
    v_permlane32_swap_b32 v66, v74
    v_permlane32_swap_b32 v67, v75
    v_permlane32_swap_b32 v68, v76
    v_permlane32_swap_b32 v69, v77
    v_permlane32_swap_b32 v70, v78
    v_permlane32_swap_b32 v71, v79
    v_add_f32 v64, v64, v72
    v_add_f32 v65, v65, v73
    v_add_f32 v66, v66, v74
    v_add_f32 v67, v67, v75
    v_add_f32 v68, v68, v76
    v_add_f32 v69, v69, v77
    v_add_f32 v70, v70, v78
    v_add_f32 v71, v71, v79
    s_nop 1
    v_permlane16_swap_b32 v64, v68
    v_permlane16_swap_b32 v65, v69
    v_permlane16_swap_b32 v66, v70
    v_permlane16_swap_b32 v67, v71
    v_add_f32 v64, v64, v68
    v_add_f32 v65, v65, v69
    v_add_f32 v66, v66, v70
    v_add_f32 v67, v67, v71
    s_nop 0
    v_add_f32_dpp v64, v64, v64 row_ror:8 row_mask:0xf bank_mask:0xf
    v_add_f32_dpp v65, v65, v65 row_ror:8 row_mask:0xf bank_mask:0xf
    v_add_f32_dpp v66, v66, v66 row_ror:8 row_mask:0xf bank_mask:0xf
    v_add_f32_dpp v67, v67, v67 row_ror:8 row_mask:0xf bank_mask:0xf
    s_nop 0
    v_add_f32_dpp v64, v64, v64 row_ror:4 row_mask:0xf bank_mask:0xf
    v_add_f32_dpp v65, v65, v65 row_ror:4 row_mask:0xf bank_mask:0xf
    v_add_f32_dpp v66, v66, v66 row_ror:4 row_mask:0xf bank_mask:0xf
    v_add_f32_dpp v67, v67, v67 row_ror:4 row_mask:0xf bank_mask:0xf
    s_nop 0
    v_add_f32_dpp v64, v64, v64 row_ror:2 row_mask:0xf bank_mask:0xf
    v_add_f32_dpp v65, v65, v65 row_ror:2 row_mask:0xf bank_mask:0xf
    v_add_f32_dpp v66, v66, v66 row_ror:2 row_mask:0xf bank_mask:0xf
    v_add_f32_dpp v67, v67, v67 row_ror:2 row_mask:0xf bank_mask:0xf
    s_nop 0
    v_add_f32_dpp v64, v64, v64 row_ror:1 row_mask:0xf bank_mask:0xf
    v_add_f32_dpp v65, v65, v65 row_ror:1 row_mask:0xf bank_mask:0xf
    v_add_f32_dpp v66, v66, v66 row_ror:1 row_mask:0xf bank_mask:0xf
    v_add_f32_dpp v67, v67, v67 row_ror:1 row_mask:0xf bank_mask:0xf
    v_and_b32 v7, 3, v1
    v_cmp_eq_u32 vcc, 1, v7
    s_nop 1
    v_cndmask_b32 v64, v64, v65, vcc
    v_cmp_eq_u32 vcc, 2, v7
    s_nop 1
    v_cndmask_b32 v64, v64, v66, vcc
    v_cmp_eq_u32 vcc, 3, v7
    s_nop 1
    v_cndmask_b32 v64, v64, v67, vcc
    v_cvt_pk_bf16_f32 v64, v64, v64
    v_and_b32 v64, s31, v64
    v_mul_f32 v64, 3216550459, v64
    v_exp_f32 v64, v64
    s_nop 0
    v_add_f32 v64, 1.0, v64
    v_rcp_f32 v64, v64
    s_nop 0
    v_cvt_pk_bf16_f32 v64, v64, v64
    v_and_b32 v64, s31, v64
    v_sub_f32 v65, 1.0, v64
    v_cvt_pk_bf16_f32 v65, v65, v65
    v_and_b32 v65, s31, v65
    v_lshl_add_u32 v7, v5, 2, v7
    v_lshlrev_b32 v7, 3, v7
    s_lshl_b32 s28, s7, 7
    s_add_u32 s28, s28, 10485760
    s_mov_b32 s34, 0x000f000f
    s_mov_b32 s35, 0x000f000f
    s_mov_b64 exec, s[34:35]
    buffer_store_dwordx2 v[64:65], v7, s[20:23], s28 offen sc1
    s_mov_b64 exec, -1
    s_waitcnt vmcnt(0)
    v_mov_b32 v3, 155148
L_lw_trv:
    s_sub_u32 s0, s0, 1
    s_cbranch_scc1 L_end
    s_sleep 4
    ds_read_b32 v4, v3
    s_waitcnt lgkmcnt(0)
    v_cmp_gt_u32 vcc, 1, v4
    s_cbranch_vccnz L_lw_trv
    s_mul_i32 s35, s6, 4352
    s_lshl_b32 s28, s3, 2
    s_add_u32 s35, s35, s28
    s_add_u32 s35, s35, 14819440
    v_mov_b32 v4, 1
    v_mov_b32 v3, 0
    s_mov_b64 exec, 1
    buffer_store_dword v4, v3, s[20:23], s35 offen sc1
    s_mov_b64 exec, -1
    s_mov_b32 s35, 0
    s_bfe_u32 s36, s2, 0x20001
    s_and_b32 s28, s2, 1
    s_xor_b32 s28, s28, 1
    s_lshl_b32 s28, s28, 2
    s_add_u32 s36, s36, s28
    s_lshl_b32 s36, s36, 2
    s_bfe_u32 s28, s2, 0x20003
    s_add_u32 s36, s36, s28
    s_lshr_b32 s37, s2, 5
    v_bfe_u32 v2, v1, 2, 2
    v_and_b32 v3, 3, v1
    v_lshrrev_b32 v4, 4, v1
    v_lshl_add_u32 v6, v4, 2, v2
    v_lshlrev_b32 v6, 7, v6
    v_lshl_add_u32 v6, v3, 3, v6
    s_lshl_b32 s42, s3, 12
    s_add_u32 s42, s42, 0
    v_add_u32 v6, s42, v6
    v_lshrrev_b32 v7, 1, v2
    v_and_b32 v4, 1, v4
    v_lshl_or_b32 v7, v4, 1, v7
    v_xor_b32 v5, 0, v7
    v_lshl_add_u32 v16, v5, 5, v6
    v_xor_b32 v5, 1, v7
    v_lshl_add_u32 v17, v5, 5, v6
    v_xor_b32 v5, 2, v7
    v_lshl_add_u32 v18, v5, 5, v6
    v_xor_b32 v5, 3, v7
    v_lshl_add_u32 v10, v5, 5, v6
    v_lshrrev_b32 v2, 3, v1
    v_and_b32 v3, 7, v1
    v_bfe_u32 v4, v1, 4, 2
    v_lshlrev_b32 v4, 1, v4
    v_xor_b32 v3, v3, v4
    v_lshlrev_b32 v2, 10, v2
    v_lshl_add_u32 v28, v3, 4, v2
    v_add_u32 v29, 7168, v28
    v_add_u32 v30, 14336, v28
    v_add_u32 v31, 21504, v28
    s_add_u32 s33, s3, 0
    s_and_b32 s33, s33, 3
    s_mul_i32 s33, s33, 57344
    v_lshl_add_u32 v24, v1, 4, s33
    s_add_u32 s33, s3, 1
    s_and_b32 s33, s33, 3
    s_mul_i32 s33, s33, 57344
    v_lshl_add_u32 v25, v1, 4, s33
    s_add_u32 s33, s3, 2
    s_and_b32 s33, s33, 3
    s_mul_i32 s33, s33, 57344
    v_lshl_add_u32 v26, v1, 4, s33
    s_add_u32 s33, s3, 3
    s_and_b32 s33, s33, 3
    s_mul_i32 s33, s33, 57344
    v_lshl_add_u32 v27, v1, 4, s33
    s_mul_i32 s38, s36, 229376
    s_mul_i32 s31, s3, 14336
    s_add_u32 s38, s38, s31
    s_mul_i32 s41, s3, 458752
    s_lshl_b32 s33, s37, 7
    s_add_u32 s41, s41, s33
    s_add_u32 s41, s41, 32768
    s_mul_i32 s39, s36, 4352
    s_mul_i32 s33, s3, 28
    s_add_u32 s39, s39, s33
    s_add_u32 s39, s39, 14680064
    s_add_u32 s40, s39, 139264
    v_min_u32 v21, 6, v1
    v_lshlrev_b32 v21, 2, v21
    s_mul_i32 s33, s3, 24
    s_sub_u32 s33, 112, s33
    v_mov_b32 v22, s33
    v_cmp_gt_u32 vcc, 7, v1
    s_nop 1
    v_cndmask_b32 v22, v22, v21, vcc
    s_lshl_b32 s28, s3, 2
    s_add_u32 s28, s28, 155152
    v_mov_b32 v19, s28
    v_mov_b32 v3, 155176
L_lw_sw1:
    s_sub_u32 s0, s0, 1
    s_cbranch_scc1 L_end
    s_sleep 2
    ds_read_b64 v[4:5], v3
    s_waitcnt lgkmcnt(0)
    v_min_u32 v4, v4, v5
    v_cmp_gt_u32 vcc, 1, v4
    s_cbranch_vccnz L_lw_sw1
    ds_read_b64_tr_b16 v[64:65], v16 offset:0
    ds_read_b64_tr_b16 v[66:67], v16 offset:2048
    ds_read_b64_tr_b16 v[68:69], v17 offset:0
    ds_read_b64_tr_b16 v[70:71], v17 offset:2048
    ds_read_b64_tr_b16 v[72:73], v18 offset:0
    ds_read_b64_tr_b16 v[74:75], v18 offset:2048
    ds_read_b64_tr_b16 v[76:77], v10 offset:0
    ds_read_b64_tr_b16 v[78:79], v10 offset:2048
    ds_read_b64_tr_b16 v[80:81], v16 offset:16384
    ds_read_b64_tr_b16 v[82:83], v16 offset:18432
    ds_read_b64_tr_b16 v[84:85], v17 offset:16384
    ds_read_b64_tr_b16 v[86:87], v17 offset:18432
    ds_read_b64_tr_b16 v[88:89], v18 offset:16384
    ds_read_b64_tr_b16 v[90:91], v18 offset:18432
    ds_read_b64_tr_b16 v[92:93], v10 offset:16384
    ds_read_b64_tr_b16 v[94:95], v10 offset:18432
    ds_read_b64_tr_b16 v[96:97], v16 offset:32768
    ds_read_b64_tr_b16 v[98:99], v16 offset:34816
    ds_read_b64_tr_b16 v[100:101], v17 offset:32768
    ds_read_b64_tr_b16 v[102:103], v17 offset:34816
    ds_read_b64_tr_b16 v[104:105], v18 offset:32768
    ds_read_b64_tr_b16 v[106:107], v18 offset:34816
    ds_read_b64_tr_b16 v[108:109], v10 offset:32768
    ds_read_b64_tr_b16 v[110:111], v10 offset:34816
    ds_read_b64_tr_b16 v[112:113], v16 offset:49152
    ds_read_b64_tr_b16 v[114:115], v16 offset:51200
    ds_read_b64_tr_b16 v[116:117], v17 offset:49152
    ds_read_b64_tr_b16 v[118:119], v17 offset:51200
    ds_read_b64_tr_b16 v[120:121], v18 offset:49152
    ds_read_b64_tr_b16 v[122:123], v18 offset:51200
    ds_read_b64_tr_b16 v[124:125], v10 offset:49152
    ds_read_b64_tr_b16 v[126:127], v10 offset:51200
    v_add_u32 v16, 65536, v16
    v_add_u32 v17, 65536, v17
    v_add_u32 v18, 65536, v18
    v_add_u32 v10, 65536, v10
    ds_read_b64_tr_b16 v[128:129], v16 offset:0
    ds_read_b64_tr_b16 v[130:131], v16 offset:2048
    ds_read_b64_tr_b16 v[132:133], v17 offset:0
    ds_read_b64_tr_b16 v[134:135], v17 offset:2048
    ds_read_b64_tr_b16 v[136:137], v18 offset:0
    ds_read_b64_tr_b16 v[138:139], v18 offset:2048
    ds_read_b64_tr_b16 v[140:141], v10 offset:0
    ds_read_b64_tr_b16 v[142:143], v10 offset:2048
    ds_read_b64_tr_b16 v[144:145], v16 offset:16384
    ds_read_b64_tr_b16 v[146:147], v16 offset:18432
    ds_read_b64_tr_b16 v[148:149], v17 offset:16384
    ds_read_b64_tr_b16 v[150:151], v17 offset:18432
    ds_read_b64_tr_b16 v[152:153], v18 offset:16384
    ds_read_b64_tr_b16 v[154:155], v18 offset:18432
    ds_read_b64_tr_b16 v[156:157], v10 offset:16384
    ds_read_b64_tr_b16 v[158:159], v10 offset:18432
    v_mov_b32 v20, 7
    s_waitcnt lgkmcnt(0)
    ds_write_b32 v19, v20
    s_branch L_g2
L_spare45:
    s_sub_u32 s6, s3, 4
    s_cmp_lg_u32 s2, 255
    s_cbranch_scc1 L_sp_bar
    s_cmp_lg_u32 s3, 4
    s_cbranch_scc1 L_sp_bar
    v_mov_b32 v4, 0
    v_mov_b32 v5, 0
    v_mov_b32 v6, 0
    v_mov_b32 v7, 0
    v_lshrrev_b32 v2, 3, v1
    v_mul_u32_u24 v2, 4352, v2
    v_and_b32 v3, 7, v1
    v_lshl_add_u32 v2, v3, 4, v2
    s_mov_b32 s28, 14680064
    buffer_store_dwordx4 v[4:7], v2, s[20:23], s28 offen sc1
    s_add_u32 s28, s28, 34816
    buffer_store_dwordx4 v[4:7], v2, s[20:23], s28 offen sc1
    s_add_u32 s28, s28, 34816
    buffer_store_dwordx4 v[4:7], v2, s[20:23], s28 offen sc1
    s_add_u32 s28, s28, 34816
    buffer_store_dwordx4 v[4:7], v2, s[20:23], s28 offen sc1
    s_add_u32 s28, s28, 34816
    buffer_store_dwordx4 v[4:7], v2, s[20:23], s28 offen sc1
    s_add_u32 s28, s28, 34816
    buffer_store_dwordx4 v[4:7], v2, s[20:23], s28 offen sc1
    s_add_u32 s28, s28, 34816
    buffer_store_dwordx4 v[4:7], v2, s[20:23], s28 offen sc1
    s_add_u32 s28, s28, 34816
    buffer_store_dwordx4 v[4:7], v2, s[20:23], s28 offen sc1
    s_add_u32 s28, s28, 34816
    buffer_store_dwordx4 v[4:7], v2, s[20:23], s28 offen sc1
    s_add_u32 s28, s28, 34816
    buffer_store_dwordx4 v[4:7], v2, s[20:23], s28 offen sc1
    s_add_u32 s28, s28, 34816
    buffer_store_dwordx4 v[4:7], v2, s[20:23], s28 offen sc1
    s_add_u32 s28, s28, 34816
    buffer_store_dwordx4 v[4:7], v2, s[20:23], s28 offen sc1
    s_add_u32 s28, s28, 34816
    s_mov_b32 s28, 15204352
    buffer_store_dwordx4 v[4:7], v2, s[20:23], s28 offen offset:0 sc1
    buffer_store_dwordx4 v[4:7], v2, s[20:23], s28 offen offset:128 sc1
    buffer_store_dwordx4 v[4:7], v2, s[20:23], s28 offen offset:256 sc1
    buffer_store_dwordx4 v[4:7], v2, s[20:23], s28 offen offset:384 sc1
    v_mov_b32 v3, 1
    s_waitcnt vmcnt(0)
    s_mov_b64 exec, 1
    global_store_dword v4, v3, s[66:67] sc1
    s_mov_b64 exec, -1
L_sp_bar:
    s_cmp_eq_u32 s6, 1
    s_cselect_b32 s12, s58, s56
    s_cselect_b32 s13, s59, s57
    s_and_b32 s13, s13, 0xffff
    s_sub_u32 s29, s2, 224
    s_mul_i32 s28, s29, 7168
    s_add_u32 s28, s28, 1835008
    v_lshlrev_b32 v2, 7, v1
    s_mov_b32 s34, -1
    s_mov_b32 s35, 0xffffff
    v_mov_b32 v17, 155216
L_lw_spring0:
    s_sub_u32 s0, s0, 1
    s_cbranch_scc1 L_end
    s_sleep 4
    ds_read_b128 v[22:25], v17
    s_waitcnt lgkmcnt(0)
    v_min_u32 v22, v22, v23
    v_min3_u32 v22, v22, v24, v25
    v_cmp_gt_u32 vcc, 1, v22
    s_cbranch_vccnz L_lw_spring0
    v_mov_b32 v17, 155184
L_lw_spun0:
    s_sub_u32 s0, s0, 1
    s_cbranch_scc1 L_end
    s_sleep 4
    ds_read_b32 v22, v17
    s_waitcnt lgkmcnt(0)
    v_cmp_gt_u32 vcc, 1, v22
    s_cbranch_vccnz L_lw_spun0
    s_mov_b64 exec, s[34:35]
    s_lshl_b32 s29, s29, 1
    s_add_u32 s29, s29, s6
    s_mul_i32 s28, s29, 28672
    buffer_load_dword v3, v2, s[16:19], s28 offen
    s_add_u32 s28, s28, 7168
    buffer_load_dword v3, v2, s[16:19], s28 offen
    s_add_u32 s28, s28, 7168
    buffer_load_dword v3, v2, s[16:19], s28 offen
    s_add_u32 s28, s28, 7168
    buffer_load_dword v3, v2, s[16:19], s28 offen
    s_add_u32 s28, s28, 7168
    s_mov_b64 exec, -1
    s_waitcnt vmcnt(0)
    v_mov_b32 v17, 155216
L_lw_spring:
    s_sub_u32 s0, s0, 1
    s_cbranch_scc1 L_end
    s_sleep 4
    ds_read_b128 v[22:25], v17
    s_waitcnt lgkmcnt(0)
    v_min_u32 v22, v22, v23
    v_min3_u32 v22, v22, v24, v25
    v_cmp_gt_u32 vcc, 1, v22
    s_cbranch_vccnz L_lw_spring
    v_mov_b32 v17, 155184
L_lw_spun:
    s_sub_u32 s0, s0, 1
    s_cbranch_scc1 L_end
    s_sleep 4
    ds_read_b32 v22, v17
    s_waitcnt lgkmcnt(0)
    v_cmp_gt_u32 vcc, 1, v22
    s_cbranch_vccnz L_lw_spun
    s_branch L_ph2_loader
L_kfin:
    s_sub_u32 s6, s3, 6
    s_lshl_b32 s7, s2, 1
    s_add_u32 s7, s7, s6
    s_lshl_b32 s30, s6, 13
    s_add_u32 s30, s30, 147456
    s_lshl_b32 s28, s7, 1
    v_mov_b32 v16, s28
    s_waitcnt lgkmcnt(0)
    s_mov_b32 s0, 0x100000
    s_mov_b32 s8, s36
    s_and_b32 s9, s37, 0xffff
    s_mov_b32 s10, 2097152
    s_mov_b32 s11, 0x00020000
    s_mov_b32 s12, s56
    s_and_b32 s13, s57, 0xffff
    s_mov_b32 s14, 1835008
    s_mov_b32 s15, 0x00020000
    s_mov_b32 s20, s68
    s_and_b32 s21, s69, 0xffff
    s_mov_b32 s22, 20971520
    s_mov_b32 s23, 0x00020000
    s_mov_b32 s16, s60
    s_and_b32 s17, s61, 0xffff
    s_mov_b32 s18, 1835008
    s_mov_b32 s19, 0x00020000
    s_mov_b32 s24, s64
    s_and_b32 s25, s65, 0xffff
    s_mov_b32 s26, 2097152
    s_mov_b32 s27, 0x00020000
    global_load_ushort v20, v16, s[52:53]
    s_cmp_eq_u32 s6, 0
    s_cbranch_scc1 L_kf_w6
    v_lshrrev_b32 v2, 3, v1
    v_and_b32 v3, 7, v1
    v_bfe_u32 v4, v1, 4, 2
    v_lshlrev_b32 v4, 1, v4
    v_xor_b32 v3, v3, v4
    v_lshlrev_b32 v2, 10, v2
    v_lshl_add_u32 v8, v3, 4, v2
    v_add_u32 v9, 7168, v8
    v_add_u32 v10, 14336, v8
    v_add_u32 v11, 21504, v8
    s_lshr_b32 s28, s2, 3
    s_lshl_b32 s28, s28, 16
    s_and_b32 s29, s2, 7
    s_lshl_b32 s29, s29, 7
    s_add_u32 s28, s28, s29
    s_mov_b32 m0, 17408
    s_nop 0
    buffer_load_dwordx4 v8, s[8:11], s28 offen offset:0 lds
    buffer_load_dwordx4 v9, s[8:11], s28 offen offset:1024 lds
    buffer_load_dwordx4 v10, s[8:11], s28 offen offset:2048 lds
    buffer_load_dwordx4 v11, s[8:11], s28 offen offset:3072 lds
    s_add_u32 s28, s28, 32768
    s_mov_b32 m0, 21504
    s_nop 0
    buffer_load_dwordx4 v8, s[8:11], s28 offen offset:0 lds
    buffer_load_dwordx4 v9, s[8:11], s28 offen offset:1024 lds
    buffer_load_dwordx4 v10, s[8:11], s28 offen offset:2048 lds
    buffer_load_dwordx4 v11, s[8:11], s28 offen offset:3072 lds
    s_add_u32 s28, s28, 32768
    s_barrier
    v_bfe_u32 v2, v1, 2, 2
    v_and_b32 v3, 3, v1
    v_lshrrev_b32 v4, 4, v1
    v_lshl_add_u32 v5, v4, 3, v2
    v_lshlrev_b32 v5, 7, v5
    v_lshl_add_u32 v5, v3, 3, v5
    v_add_u32 v5, 17408, v5
    v_lshrrev_b32 v6, 1, v2
    v_xor_b32 v7, 0, v6
    v_lshl_add_u32 v64, v7, 5, v5
    v_xor_b32 v7, 1, v6
    v_lshl_add_u32 v65, v7, 5, v5
    v_xor_b32 v7, 2, v6
    v_lshl_add_u32 v66, v7, 5, v5
    v_xor_b32 v7, 3, v6
    v_lshl_add_u32 v67, v7, 5, v5
    v_and_b32 v6, 15, v1
    v_mul_u32_u24 v6, 144, v6
    v_lshl_add_u32 v6, v4, 4, v6
    v_add_u32 v68, 25600, v6
    v_lshrrev_b32 v6, 3, v1
    v_and_b32 v7, 7, v1
    v_mul_u32_u24 v2, 144, v6
    v_lshl_add_u32 v2, v7, 4, v2
    v_add_u32 v69, 25600, v2
    s_waitcnt vmcnt(0)
    ds_read_b64_tr_b16 v[72:73], v64 offset:0
    ds_read_b64_tr_b16 v[74:75], v66 offset:512
    ds_read_b64_tr_b16 v[76:77], v64 offset:4096
    ds_read_b64_tr_b16 v[78:79], v66 offset:4608
    ds_read_b64_tr_b16 v[80:81], v65 offset:0
    ds_read_b64_tr_b16 v[82:83], v67 offset:512
    ds_read_b64_tr_b16 v[84:85], v65 offset:4096
    ds_read_b64_tr_b16 v[86:87], v67 offset:4608
    ds_read_b64_tr_b16 v[88:89], v66 offset:0
    ds_read_b64_tr_b16 v[90:91], v64 offset:512
    ds_read_b64_tr_b16 v[92:93], v66 offset:4096
    ds_read_b64_tr_b16 v[94:95], v64 offset:4608
    ds_read_b64_tr_b16 v[96:97], v67 offset:0
    ds_read_b64_tr_b16 v[98:99], v65 offset:512
    ds_read_b64_tr_b16 v[100:101], v67 offset:4096
    ds_read_b64_tr_b16 v[102:103], v65 offset:4608
    s_waitcnt lgkmcnt(14)
    ds_write_b128 v68, v[72:75] offset:0
    s_waitcnt lgkmcnt(13)
    ds_write_b128 v68, v[76:79] offset:64
    s_waitcnt lgkmcnt(12)
    ds_write_b128 v68, v[80:83] offset:2304
    s_waitcnt lgkmcnt(11)
    ds_write_b128 v68, v[84:87] offset:2368
    s_waitcnt lgkmcnt(10)
    ds_write_b128 v68, v[88:91] offset:4608
    s_waitcnt lgkmcnt(9)
    ds_write_b128 v68, v[92:95] offset:4672
    s_waitcnt lgkmcnt(8)
    ds_write_b128 v68, v[96:99] offset:6912
    s_waitcnt lgkmcnt(7)
    ds_write_b128 v68, v[100:103] offset:6976
    ds_read_b128 v[224:227], v69 offset:0
    ds_read_b128 v[228:231], v69 offset:1152
    ds_read_b128 v[232:235], v69 offset:2304
    ds_read_b128 v[236:239], v69 offset:3456
    ds_read_b128 v[240:243], v69 offset:4608
    ds_read_b128 v[244:247], v69 offset:5760
    ds_read_b128 v[248:251], v69 offset:6912
    ds_read_b128 v[252:255], v69 offset:8064
    s_waitcnt lgkmcnt(0)
    v_mov_b32 v2, 155184
    v_mov_b32 v3, 1
    ds_write_b32 v2, v3
    s_branch L_kf_go
L_walk_ret:
    s_setpc_b64 s[46:47]
L_kf_w6:
    s_barrier
L_kf_go:
    v_and_b32 v6, 15, v1
    v_lshrrev_b32 v7, 4, v1
    v_and_b32 v2, 3, v6
    v_lshrrev_b32 v3, 2, v6
    v_lshl_add_u32 v6, v2, 2, v3
    v_lshrrev_b32 v12, 1, v7
    v_and_b32 v13, 1, v7
    v_lshlrev_b32 v8, 8, v12
    v_lshl_add_u32 v8, v13, 1, v8
    v_lshl_add_u32 v8, v6, 4, v8
    v_add_u32 v8, s30, v8
    v_lshlrev_b32 v2, 7, v13
    v_lshl_add_u32 v2, v6, 3, v2
    v_lshlrev_b32 v3, 1, v13
    v_lshl_add_u32 v3, v6, 2, v3
    v_add_u32 v3, 256, v3
    v_cmp_eq_u32 vcc, 0, v12
    v_mul_u32_u24 v14, 62, v12
    v_add_u32 v14, 2, v14
    v_cndmask_b32 v16, v3, v2, vcc
    v_add_u32 v16, s30, v16
    v_add_u32 v17, v16, v14
    v_add_u32 v18, v17, v14
    v_add_u32 v19, v18, v14
    v_lshlrev_b32 v11, 5, v7
    v_mul_u32_u24 v2, 192, v12
    v_add3_u32 v11, v11, v2, s30
    v_lshl_add_u32 v11, v6, 1, v11
    v_sub_u32 v56, 63, v1
    v_lshrrev_b32 v57, 4, v56
    v_min_u32 v57, 2, v57
    v_lshlrev_b32 v58, 5, v56
    v_lshrrev_b32 v58, v57, v58
    v_lshl_add_u32 v58, v57, 8, v58
    v_add_u32 v58, s30, v58
    v_lshlrev_b32 v57, 3, v57
    s_mov_b32 s35, 0
    v_bfe_u32 v36, s35, v57, 8
    v_add_u32 v36, v36, v58
    s_mov_b32 s35, 2
    v_bfe_u32 v37, s35, v57, 8
    v_add_u32 v37, v37, v58
    s_mov_b32 s35, 516
    v_bfe_u32 v38, s35, v57, 8
    v_add_u32 v38, v38, v58
    s_mov_b32 s35, 132102
    v_bfe_u32 v39, s35, v57, 8
    v_add_u32 v39, v39, v58
    s_mov_b32 s35, 132104
    v_bfe_u32 v40, s35, v57, 8
    v_add_u32 v40, v40, v58
    s_mov_b32 s35, 132106
    v_bfe_u32 v41, s35, v57, 8
    v_add_u32 v41, v41, v58
    s_mov_b32 s35, 263692
    v_bfe_u32 v42, s35, v57, 8
    v_add_u32 v42, v42, v58
    s_mov_b32 s35, 264206
    v_bfe_u32 v43, s35, v57, 8
    v_add_u32 v43, v43, v58
    s_mov_b32 s35, 264208
    v_bfe_u32 v44, s35, v57, 8
    v_add_u32 v44, v44, v58
    s_mov_b32 s35, 264210
    v_bfe_u32 v45, s35, v57, 8
    v_add_u32 v45, v45, v58
    s_mov_b32 s35, 264724
    v_bfe_u32 v46, s35, v57, 8
    v_add_u32 v46, v46, v58
    s_mov_b32 s35, 396310
    v_bfe_u32 v47, s35, v57, 8
    v_add_u32 v47, v47, v58
    s_mov_b32 s35, 396312
    v_bfe_u32 v48, s35, v57, 8
    v_add_u32 v48, v48, v58
    s_mov_b32 s35, 396314
    v_bfe_u32 v49, s35, v57, 8
    v_add_u32 v49, v49, v58
    s_mov_b32 s35, 527900
    v_bfe_u32 v50, s35, v57, 8
    v_add_u32 v50, v50, v58
    s_mov_b32 s35, 528414
    v_bfe_u32 v51, s35, v57, 8
    v_add_u32 v51, v51, v58
    s_mov_b32 s35, 528416
    v_bfe_u32 v52, s35, v57, 8
    v_add_u32 v52, v52, v58
    v_lshl_add_u32 v56, v56, 2, s30
    v_lshl_add_u32 v5, v1, 4, s30
    s_lshr_b32 s29, s7, 6
    s_lshl_b32 s29, s29, 2
    s_and_b32 s28, s2, 3
    s_add_u32 s29, s29, s28
    s_mul_i32 s29, s29, 4352
    s_add_u32 s35, s29, 14958592
    v_and_b32 v54, 31, v1
    v_lshlrev_b32 v54, 2, v54
    s_lshl_b32 s31, s7, 12
    s_add_u32 s31, s31, 8388608
    v_lshlrev_b32 v53, 4, v1
    s_lshl_b32 s28, s6, 3
    s_add_u32 s28, s28, 155216
    v_mov_b32 v2, s28
L_lw_kf:
    s_sub_u32 s0, s0, 1
    s_cbranch_scc1 L_end
    s_sleep 1
    ds_read_b64 v[60:61], v2
    s_waitcnt lgkmcnt(0)
    v_min_u32 v60, v60, v61
    v_cmp_gt_u32 vcc, 1, v60
    s_cbranch_vccnz L_lw_kf
    ds_read_b128 v[96:99], v5 offset:0
    ds_read_b128 v[100:103], v5 offset:1024
    ds_read_b128 v[104:107], v5 offset:2048
    ds_read_b128 v[108:111], v5 offset:3072
    ds_read_b128 v[112:115], v5 offset:4096
    ds_read_b128 v[116:119], v5 offset:5120
    s_waitcnt lgkmcnt(0)
    v_add_f32 v96, v96, v108
    v_add_f32 v97, v97, v109
    v_add_f32 v98, v98, v110
    v_add_f32 v99, v99, v111
    v_add_f32 v100, v100, v112
    v_add_f32 v101, v101, v113
    v_add_f32 v102, v102, v114
    v_add_f32 v103, v103, v115
    v_add_f32 v104, v104, v116
    v_add_f32 v105, v105, v117
    v_add_f32 v106, v106, v118
    v_add_f32 v107, v107, v119
    v_cvt_pk_bf16_f32 v64, v96, v97
    v_cvt_pk_bf16_f32 v65, v98, v99
    v_cvt_pk_bf16_f32 v66, v100, v101
    v_cvt_pk_bf16_f32 v67, v102, v103
    v_cvt_pk_bf16_f32 v68, v104, v105
    v_cvt_pk_bf16_f32 v69, v106, v107
    ds_write_b16 v8, v64 offset:6144
    ds_write_b16 v16, v66 offset:6656
    ds_write_b16 v11, v68 offset:7168
    ds_write_b16_d16_hi v8, v64 offset:6148
    ds_write_b16_d16_hi v17, v66 offset:6656
    ds_write_b16_d16_hi v11, v68 offset:7232
    ds_write_b16 v8, v65 offset:6152
    ds_write_b16 v18, v67 offset:6656
    ds_write_b16 v11, v69 offset:7296
    ds_write_b16_d16_hi v8, v65 offset:6156
    ds_write_b16_d16_hi v19, v67 offset:6656
    ds_write_b16_d16_hi v11, v69 offset:7360
    v_mov_b32 v2, 0
    v_mov_b32 v3, 0
    v_lshl_add_u32 v4, v1, 3, s30
    ds_write_b64 v4, v[2:3] offset:0
    ds_read_b32 v72, v56 offset:7168
    ds_read_u16 v73, v56 offset:7172
    ds_read_u16 v208, v51 offset:6144
    ds_read_u16 v216, v50 offset:6144
    ds_read_u16 v209, v49 offset:6144
    ds_read_u16 v217, v48 offset:6144
    ds_read_u16 v210, v47 offset:6144
    ds_read_u16 v218, v46 offset:6144
    ds_read_u16 v211, v45 offset:6144
    ds_read_u16 v219, v44 offset:6144
    ds_read_u16 v212, v43 offset:6144
    ds_read_u16 v220, v42 offset:6144
    ds_read_u16 v213, v41 offset:6144
    ds_read_u16 v221, v40 offset:6144
    ds_read_u16 v214, v39 offset:6144
    ds_read_u16 v222, v38 offset:6144
    ds_read_u16 v215, v37 offset:6144
    ds_read_u16 v223, v36 offset:6144
    ds_read_u16 v74, v52 offset:6144
    s_cmp_ge_u32 s2, 224
    s_cbranch_scc1 L_bar3
    s_barrier
L_bar3:
    s_cmp_lg_u32 s6, 1
    s_cbranch_scc1 L_kf_ns
    v_lshrrev_b32 v24, 3, v1
    v_and_b32 v25, 7, v1
    v_lshlrev_b32 v24, 12, v24
    v_lshl_add_u32 v24, v25, 4, v24
    s_and_b32 s28, s2, 7
    s_lshl_b32 s28, s28, 18
    s_lshr_b32 s34, s2, 3
    s_lshl_b32 s34, s34, 7
    s_add_u32 s28, s28, s34
    s_add_u32 s28, s28, 8388608
    buffer_store_dwordx4 v[224:227], v24, s[20:23], s28 offen sc1
    s_add_u32 s28, s28, 32768
    buffer_store_dwordx4 v[228:231], v24, s[20:23], s28 offen sc1
    s_add_u32 s28, s28, 32768
    buffer_store_dwordx4 v[232:235], v24, s[20:23], s28 offen sc1
    s_add_u32 s28, s28, 32768
    buffer_store_dwordx4 v[236:239], v24, s[20:23], s28 offen sc1
    s_add_u32 s28, s28, 32768
    buffer_store_dwordx4 v[240:243], v24, s[20:23], s28 offen sc1
    s_add_u32 s28, s28, 32768
    buffer_store_dwordx4 v[244:247], v24, s[20:23], s28 offen sc1
    s_add_u32 s28, s28, 32768
    buffer_store_dwordx4 v[248:251], v24, s[20:23], s28 offen sc1
    s_add_u32 s28, s28, 32768
    buffer_store_dwordx4 v[252:255], v24, s[20:23], s28 offen sc1
    s_add_u32 s28, s28, 32768
L_kf_ns:
    s_cmp_ge_u32 s2, 224
    s_cbranch_scc1 L_bar4
    s_barrier
L_bar4:
    v_mov_b32 v22, 0
    s_cmp_lg_u32 s6, 0
    s_cbranch_scc1 L_kf_nv0
    global_load_dword v23, v22, s[66:67] sc1
L_kf_nv0:
    s_mov_b32 s28, 0x01000100
    s_mov_b32 s29, 0x03020302
    s_mov_b32 s34, 0x01000302
    s_mov_b32 s1, 0x03020504
    s_waitcnt lgkmcnt(0)
    v_perm_b32 v192, v73, v73, s28
    v_perm_b32 v194, v72, v72, s29
    v_perm_b32 v198, v72, v72, s28
    v_perm_b32 v197, v72, v72, s34
    v_perm_b32 v202, v73, v72, s1
    v_mov_b32 v193, v192
    v_mov_b32 v195, v194
    v_mov_b32 v196, v194
    v_mov_b32 v199, v198
    v_mov_b32 v200, v192
    v_mov_b32 v201, v192
    v_mov_b32 v203, v194
    v_mov_b32 v204, v194
    v_mov_b32 v205, v194
    v_mov_b32 v206, v198
    v_mov_b32 v207, v198
    v_lshl_or_b32 v208, v216, 16, v208
    v_lshl_or_b32 v209, v217, 16, v209
    v_lshl_or_b32 v210, v218, 16, v210
    v_lshl_or_b32 v211, v219, 16, v211
    v_lshl_or_b32 v212, v220, 16, v212
    v_lshl_or_b32 v213, v221, 16, v213
    v_lshl_or_b32 v214, v222, 16, v214
    v_lshl_or_b32 v215, v223, 16, v215
    v_lshl_or_b32 v216, v208, 16, v74
    v_alignbit_b32 v217, v209, v208, 16
    v_alignbit_b32 v218, v210, v209, 16
    v_alignbit_b32 v219, v211, v210, 16
    v_alignbit_b32 v220, v212, v211, 16
    v_alignbit_b32 v221, v213, v212, 16
    v_alignbit_b32 v222, v214, v213, 16
    v_alignbit_b32 v223, v215, v214, 16
    v_lshrrev_b32 v8, 16, v215
    v_mov_b32 v9, 0
    v_mov_b32 v10, 0
    v_mov_b32 v11, 0
    v_mov_b32 v12, 0
    v_mov_b32 v13, 0
    v_mov_b32 v14, 0
    v_mov_b32 v15, 0
    s_mul_i32 s29, s6, 8320
    s_add_u32 s29, s29, 114688
    v_lshl_add_u32 v21, v1, 5, s29
    s_cmp_ge_u32 s2, 224
    s_cbranch_scc1 L_bar5
    s_barrier
L_bar5:
    s_cmp_lg_u32 s6, 0
    s_cbranch_scc1 L_kf_nv
    s_waitcnt vmcnt(0)
    v_cmp_eq_u32 vcc, 0, v23
    s_cbranch_vccz L_kf_vok
L_kf_vpoll:
    s_sub_u32 s0, s0, 1
    s_cbranch_scc1 L_end
    s_sleep 8
    global_load_dword v23, v22, s[66:67] sc1
    s_waitcnt vmcnt(0)
    v_cmp_eq_u32 vcc, 0, v23
    s_cbranch_vccnz L_kf_vpoll
L_kf_vok:
    v_mov_b32 v2, 155148
    v_mov_b32 v3, 1
    ds_write_b32 v2, v3
L_kf_nv:
    s_cmp_ge_u32 s2, 224
    s_cbranch_scc1 L_bar6
    s_barrier
L_bar6:
    s_cmp_lg_u32 s6, 1
    s_cbranch_scc1 L_kf_np
    s_and_b32 s28, s2, 7
    s_mul_i32 s28, s28, 17408
    s_lshr_b32 s29, s2, 3
    s_lshl_b32 s29, s29, 2
    s_add_u32 s28, s28, s29
    s_add_u32 s28, s28, 14958592
    v_mul_u32_u24 v2, 4352, v1
    v_mov_b32 v3, 1
    v_mov_b32 v4, 155148
L_lw_unv:
    s_sub_u32 s0, s0, 1
    s_cbranch_scc1 L_end
    s_sleep 2
    ds_read_b32 v60, v4
    s_waitcnt lgkmcnt(0)
    v_cmp_gt_u32 vcc, 1, v60
    s_cbranch_vccnz L_lw_unv
    s_waitcnt vmcnt(0)
    s_mov_b64 exec, 15
    buffer_store_dword v3, v2, s[20:23], s28 offen sc1
    s_mov_b64 exec, -1
L_kf_np:
    s_cmp_ge_u32 s2, 224
    s_cbranch_scc1 L_bar7
    s_barrier
L_bar7:
    s_cmp_ge_u32 s2, 224
    s_cbranch_scc1 L_bar8
    s_barrier
L_bar8:
    v_mov_b32 v5, 155148
L_lw_kfv:
    s_sub_u32 s0, s0, 1
    s_cbranch_scc1 L_end
    s_sleep 2
    ds_read_b32 v60, v5
    s_waitcnt lgkmcnt(0)
    v_cmp_gt_u32 vcc, 1, v60
    s_cbranch_vccnz L_lw_kfv
    s_cmp_ge_u32 s2, 224
    s_cselect_b32 s28, 0x7ffffff0, s35
    buffer_load_dword v55, v54, s[20:23], s28 offen sc1
    s_cmp_ge_u32 s2, 224
    s_cbranch_scc1 L_bar9
    s_barrier
L_bar9:
    s_waitcnt vmcnt(0)
    v_cmp_ne_u32 s[32:33], 1, v55
    s_nop 2
    s_cmp_lg_u64 s[32:33], 0
    s_cbranch_scc1 L_kf_late
    s_add_u32 m0, s30, 512
    s_nop 0
    buffer_load_dwordx4 v53, s[20:23], s31 offen offset:0 sc1 lds
    buffer_load_dwordx4 v53, s[20:23], s31 offen offset:1024 sc1 lds
    buffer_load_dwordx4 v53, s[20:23], s31 offen offset:2048 sc1 lds
    buffer_load_dwordx4 v53, s[20:23], s31 offen offset:3072 sc1 lds
L_kf_late:
    s_cmp_ge_u32 s2, 224
    s_cbranch_scc1 L_bar10
    s_barrier
L_bar10:
    s_cmp_ge_u32 s2, 224
    s_cbranch_scc1 L_bar11
    s_barrier
L_bar11:
    ds_write_b128 v21, v[192:195] offset:0
    ds_write_b128 v21, v[200:203] offset:4160
    ds_write_b128 v21, v[196:199] offset:16
    ds_write_b128 v21, v[204:207] offset:4176
    ds_write_b128 v21, v[208:211] offset:2048
    ds_write_b128 v21, v[216:219] offset:6208
    ds_write_b128 v21, v[212:215] offset:2064
    ds_write_b128 v21, v[220:223] offset:6224
    s_mov_b32 s28, 0
    s_mov_b32 s29, 0x80000000
    s_mov_b64 exec, s[28:29]
    ds_write_b128 v21, v[12:15] offset:2080
    ds_write_b128 v21, v[12:15] offset:2096
    ds_write_b128 v21, v[8:11] offset:6240
    ds_write_b128 v21, v[12:15] offset:6256
    s_mov_b64 exec, -1
    s_cmp_eq_u64 s[32:33], 0
    s_cbranch_scc1 L_kf_uok
    s_cmp_lt_u32 s2, 224
    s_cbranch_scc1 L_kf_up0
    v_mov_b32 v5, 155152
L_lw_kfsp:
    s_sub_u32 s0, s0, 1
    s_cbranch_scc1 L_end
    s_sleep 4
    ds_read_b128 v[60:63], v5
    s_waitcnt lgkmcnt(0)
    v_min_u32 v60, v60, v61
    v_min3_u32 v60, v60, v62, v63
    v_cmp_gt_u32 vcc, 7, v60
    s_cbranch_vccnz L_lw_kfsp
    buffer_load_dword v55, v54, s[20:23], s35 offen sc1
    s_waitcnt vmcnt(0)
    v_cmp_ne_u32 vcc, 1, v55
    s_cbranch_vccz L_kf_up3
L_kf_up0:
L_kf_upoll:
    s_sub_u32 s0, s0, 1
    s_cbranch_scc1 L_end
    s_sleep 8
    s_cmp_lt_u32 s2, 224
    s_cbranch_scc1 L_kf_up2
    s_sleep 20
L_kf_up2:
    buffer_load_dword v55, v54, s[20:23], s35 offen sc1
    s_waitcnt vmcnt(0)
    v_cmp_ne_u32 vcc, 1, v55
    s_cbranch_vccnz L_kf_upoll
L_kf_up3:
    s_add_u32 m0, s30, 512
    s_nop 0
    buffer_load_dwordx4 v53, s[20:23], s31 offen offset:0 sc1 lds
    buffer_load_dwordx4 v53, s[20:23], s31 offen offset:1024 sc1 lds
    buffer_load_dwordx4 v53, s[20:23], s31 offen offset:2048 sc1 lds
    buffer_load_dwordx4 v53, s[20:23], s31 offen offset:3072 sc1 lds
L_kf_uok:
    s_lshl_b32 s28, s6, 2
    s_add_u32 s28, s28, 155168
    s_waitcnt vmcnt(0)
    v_mov_b32 v16, s28
    v_mov_b32 v17, 1
    ds_write_b32 v16, v17
    s_mov_b32 s33, 0
L_conv:
    v_and_b32 v2, 15, v1
    v_lshrrev_b32 v3, 4, v1
    s_lshl_b32 s32, s33, 8
    s_mul_i32 s29, s6, 8320
    s_add_u32 s29, s29, 122912
    s_sub_u32 s29, s29, s32
    v_add_u32 v4, 1, v2
    v_lshrrev_b32 v4, 1, v4
    v_lshlrev_b32 v5, 2, v3
    v_sub_u32 v5, v5, v4
    v_lshl_add_u32 v5, v5, 2, s29
    v_and_b32 v4, 1, v2
    v_mul_u32_u24 v4, 4160, v4
    v_sub_u32 v5, v5, v4
    v_subrev_u32 v8, 512, v5
    v_subrev_u32 v9, 1536, v5
    v_subrev_u32 v10, 2560, v5
    v_subrev_u32 v11, 3584, v5
    v_lshlrev_b32 v4, 5, v2
    v_lshl_add_u32 v4, v3, 4, v4
    s_add_u32 s28, s30, 480
    s_sub_u32 s28, s28, s32
    v_add_u32 v12, s28, v4
    s_add_u32 s28, s30, 4608
    s_lshl_b32 s29, s6, 11
    s_add_u32 s29, s29, 139520
    s_cmp_eq_u32 s33, 0
    s_cselect_b32 s34, s28, s29
    s_cselect_b32 s35, s29, s28
    v_lshl_add_u32 v13, v1, 4, s34
    v_lshl_add_u32 v14, v1, 4, s35
    s_lshl_b32 s24, s6, 3
    s_lshl_b32 s29, s33, 2
    s_add_u32 s24, s24, s29
    s_add_u32 s24, s24, 155232
    s_xor_b32 s25, s24, 4
    v_lshlrev_b32 v4, 5, v2
    v_lshl_add_u32 v4, v3, 3, v4
    s_lshl_b32 s32, s33, 11
    s_add_u32 s34, s30, 512
    s_add_u32 s34, s34, s32
    v_add_u32 v5, s34, v4
    ds_read_b64 v[192:193], v5 offset:0
    ds_read_b64 v[194:195], v5 offset:512
    ds_read_b64 v[196:197], v5 offset:1024
    ds_read_b64 v[198:199], v5 offset:1536
    s_mov_b32 s31, 0xffff0000
    v_lshlrev_b32 v20, 16, v20
    v_lshlrev_b32 v6, 5, v2
    v_lshrrev_b32 v7, 1, v3
    v_lshl_add_u32 v6, v7, 4, v6
    v_and_b32 v7, 1, v3
    v_lshl_add_u32 v6, v7, 9, v6
    s_lshl_b32 s26, s7, 12
    s_add_u32 s26, s26, s32
    s_add_u32 s26, s26, 11534336
    s_lshr_b32 s27, s7, 6
    s_mul_i32 s27, s27, 4352
    s_and_b32 s29, s7, 63
    s_lshl_b32 s29, s29, 2
    s_add_u32 s27, s27, s29
    s_lshl_b32 s29, s33, 8
    s_add_u32 s27, s27, s29
    s_add_u32 s27, s27, 15204352
    v_mov_b32 v15, s24
    v_mov_b32 v19, 1
    s_cmp_eq_u32 s33, 0
    s_cselect_b32 s28, 1.0, 0
    s_cselect_b32 s29, 0, 1.0
    v_mul_f32 v22, s28, v20
    v_mul_f32 v23, s29, v20
    s_waitcnt lgkmcnt(0)
    v_lshlrev_b32 v216, 16, v192
    v_and_b32 v217, s31, v192
    v_mul_f32 v24, v216, v22
    v_mul_f32 v25, v217, v22
    v_mul_f32 v40, v216, v23
    v_mul_f32 v41, v217, v23
    v_lshlrev_b32 v216, 16, v193
    v_and_b32 v217, s31, v193
    v_mul_f32 v26, v216, v22
    v_mul_f32 v27, v217, v22
    v_mul_f32 v42, v216, v23
    v_mul_f32 v43, v217, v23
    v_lshlrev_b32 v216, 16, v194
    v_and_b32 v217, s31, v194
    v_mul_f32 v28, v216, v22
    v_mul_f32 v29, v217, v22
    v_mul_f32 v44, v216, v23
    v_mul_f32 v45, v217, v23
    v_lshlrev_b32 v216, 16, v195
    v_and_b32 v217, s31, v195
    v_mul_f32 v30, v216, v22
    v_mul_f32 v31, v217, v22
    v_mul_f32 v46, v216, v23
    v_mul_f32 v47, v217, v23
    v_lshlrev_b32 v216, 16, v196
    v_and_b32 v217, s31, v196
    v_mul_f32 v32, v216, v22
    v_mul_f32 v33, v217, v22
    v_mul_f32 v48, v216, v23
    v_mul_f32 v49, v217, v23
    v_lshlrev_b32 v216, 16, v197
    v_and_b32 v217, s31, v197
    v_mul_f32 v34, v216, v22
    v_mul_f32 v35, v217, v22
    v_mul_f32 v50, v216, v23
    v_mul_f32 v51, v217, v23
    v_lshlrev_b32 v216, 16, v198
    v_and_b32 v217, s31, v198
    v_mul_f32 v36, v216, v22
    v_mul_f32 v37, v217, v22
    v_mul_f32 v52, v216, v23
    v_mul_f32 v53, v217, v23
    v_lshlrev_b32 v216, 16, v199
    v_and_b32 v217, s31, v199
    v_mul_f32 v38, v216, v22
    v_mul_f32 v39, v217, v22
    v_mul_f32 v54, v216, v23
    v_mul_f32 v55, v217, v23
    ds_read2_b32 v[64:65], v8 offset0:128 offset1:129
    ds_read2_b32 v[66:67], v8 offset0:130 offset1:131
    ds_read_b128 v[96:99], v12 offset:0
    ds_read2_b32 v[68:69], v8 offset0:0 offset1:1
    ds_read2_b32 v[70:71], v8 offset0:2 offset1:3
    ds_read_b128 v[100:103], v12 offset:512
    ds_read2_b32 v[72:73], v9 offset0:128 offset1:129
    ds_read2_b32 v[74:75], v9 offset0:130 offset1:131
    ds_read_b128 v[104:107], v12 offset:1024
    ds_read2_b32 v[76:77], v9 offset0:0 offset1:1
    ds_read2_b32 v[78:79], v9 offset0:2 offset1:3
    ds_read_b128 v[108:111], v12 offset:1536
    ds_read2_b32 v[80:81], v10 offset0:128 offset1:129
    ds_read2_b32 v[82:83], v10 offset0:130 offset1:131
    ds_read_b128 v[112:115], v12 offset:2048
    ds_read2_b32 v[84:85], v10 offset0:0 offset1:1
    ds_read2_b32 v[86:87], v10 offset0:2 offset1:3
    ds_read_b128 v[116:119], v12 offset:2560
    ds_read2_b32 v[88:89], v11 offset0:128 offset1:129
    ds_read2_b32 v[90:91], v11 offset0:130 offset1:131
    ds_read_b128 v[120:123], v12 offset:3072
    ds_read2_b32 v[92:93], v11 offset0:0 offset1:1
    ds_read2_b32 v[94:95], v11 offset0:2 offset1:3
    ds_read_b128 v[124:127], v12 offset:3584
    v_subrev_u32 v8, 64, v8
    v_subrev_u32 v9, 64, v9
    v_subrev_u32 v10, 64, v10
    v_subrev_u32 v11, 64, v11
    v_subrev_u32 v12, 64, v12
    s_lshl_b32 s28, s3, 2
    s_add_u32 s28, s28, 155136
    v_mov_b32 v16, s28
L_lw_cve:
    s_sub_u32 s0, s0, 1
    s_cbranch_scc1 L_end
    s_sleep 2
    ds_read_b32 v18, v16
    s_waitcnt lgkmcnt(0)
    v_cmp_gt_u32 vcc, 7, v18
    s_cbranch_vccnz L_lw_cve
    s_mov_b32 s28, 2
L_cv_loop:
    s_waitcnt lgkmcnt(0)
    v_mfma_f32_16x16x32_bf16 v[24:27], v[64:67], v[96:99], v[24:27]
    ds_read2_b32 v[128:129], v8 offset0:128 offset1:129
    v_mfma_f32_16x16x32_bf16 v[28:31], v[64:67], v[100:103], v[28:31]
    ds_read2_b32 v[130:131], v8 offset0:130 offset1:131
    v_mfma_f32_16x16x32_bf16 v[32:35], v[64:67], v[104:107], v[32:35]
    ds_read_b128 v[160:163], v12 offset:0
    v_mfma_f32_16x16x32_bf16 v[36:39], v[64:67], v[108:111], v[36:39]
    ds_read2_b32 v[132:133], v8 offset0:0 offset1:1
    v_mfma_f32_16x16x32_bf16 v[40:43], v[64:67], v[112:115], v[40:43]
    ds_read2_b32 v[134:135], v8 offset0:2 offset1:3
    v_mfma_f32_16x16x32_bf16 v[44:47], v[64:67], v[116:119], v[44:47]
    ds_read_b128 v[164:167], v12 offset:512
    v_mfma_f32_16x16x32_bf16 v[48:51], v[64:67], v[120:123], v[48:51]
    ds_read2_b32 v[136:137], v9 offset0:128 offset1:129
    v_mfma_f32_16x16x32_bf16 v[52:55], v[64:67], v[124:127], v[52:55]
    ds_read2_b32 v[138:139], v9 offset0:130 offset1:131
    v_mfma_f32_16x16x32_bf16 v[28:31], v[68:71], v[96:99], v[28:31]
    ds_read_b128 v[168:171], v12 offset:1024
    v_mfma_f32_16x16x32_bf16 v[32:35], v[68:71], v[100:103], v[32:35]
    ds_read2_b32 v[140:141], v9 offset0:0 offset1:1
    v_mfma_f32_16x16x32_bf16 v[36:39], v[68:71], v[104:107], v[36:39]
    ds_read2_b32 v[142:143], v9 offset0:2 offset1:3
    v_mfma_f32_16x16x32_bf16 v[40:43], v[68:71], v[108:111], v[40:43]
    ds_read_b128 v[172:175], v12 offset:1536
    v_mfma_f32_16x16x32_bf16 v[44:47], v[68:71], v[112:115], v[44:47]
    ds_read2_b32 v[144:145], v10 offset0:128 offset1:129
    v_mfma_f32_16x16x32_bf16 v[48:51], v[68:71], v[116:119], v[48:51]
    ds_read2_b32 v[146:147], v10 offset0:130 offset1:131
    v_mfma_f32_16x16x32_bf16 v[52:55], v[68:71], v[120:123], v[52:55]
    ds_read_b128 v[176:179], v12 offset:2048
    v_mfma_f32_16x16x32_bf16 v[32:35], v[72:75], v[96:99], v[32:35]
    ds_read2_b32 v[148:149], v10 offset0:0 offset1:1
    v_mfma_f32_16x16x32_bf16 v[36:39], v[72:75], v[100:103], v[36:39]
    ds_read2_b32 v[150:151], v10 offset0:2 offset1:3
    v_mfma_f32_16x16x32_bf16 v[40:43], v[72:75], v[104:107], v[40:43]
    ds_read_b128 v[180:183], v12 offset:2560
    v_mfma_f32_16x16x32_bf16 v[44:47], v[72:75], v[108:111], v[44:47]
    ds_read2_b32 v[152:153], v11 offset0:128 offset1:129
    v_mfma_f32_16x16x32_bf16 v[48:51], v[72:75], v[112:115], v[48:51]
    ds_read2_b32 v[154:155], v11 offset0:130 offset1:131
    v_mfma_f32_16x16x32_bf16 v[52:55], v[72:75], v[116:119], v[52:55]
    ds_read_b128 v[184:187], v12 offset:3072
    v_mfma_f32_16x16x32_bf16 v[36:39], v[76:79], v[96:99], v[36:39]
    ds_read2_b32 v[156:157], v11 offset0:0 offset1:1
    v_mfma_f32_16x16x32_bf16 v[40:43], v[76:79], v[100:103], v[40:43]
    ds_read2_b32 v[158:159], v11 offset0:2 offset1:3
    v_mfma_f32_16x16x32_bf16 v[44:47], v[76:79], v[104:107], v[44:47]
    ds_read_b128 v[188:191], v12 offset:3584
    v_mfma_f32_16x16x32_bf16 v[48:51], v[76:79], v[108:111], v[48:51]
    v_subrev_u32 v8, 64, v8
    v_mfma_f32_16x16x32_bf16 v[52:55], v[76:79], v[112:115], v[52:55]
    v_subrev_u32 v9, 64, v9
    v_mfma_f32_16x16x32_bf16 v[40:43], v[80:83], v[96:99], v[40:43]
    v_subrev_u32 v10, 64, v10
    v_mfma_f32_16x16x32_bf16 v[44:47], v[80:83], v[100:103], v[44:47]
    v_subrev_u32 v11, 64, v11
    v_mfma_f32_16x16x32_bf16 v[48:51], v[80:83], v[104:107], v[48:51]
    v_subrev_u32 v12, 64, v12
    v_mfma_f32_16x16x32_bf16 v[52:55], v[80:83], v[108:111], v[52:55]
    v_mfma_f32_16x16x32_bf16 v[44:47], v[84:87], v[96:99], v[44:47]
    v_mfma_f32_16x16x32_bf16 v[48:51], v[84:87], v[100:103], v[48:51]
    v_mfma_f32_16x16x32_bf16 v[52:55], v[84:87], v[104:107], v[52:55]
    v_mfma_f32_16x16x32_bf16 v[48:51], v[88:91], v[96:99], v[48:51]
    v_mfma_f32_16x16x32_bf16 v[52:55], v[88:91], v[100:103], v[52:55]
    v_mfma_f32_16x16x32_bf16 v[52:55], v[92:95], v[96:99], v[52:55]
    s_waitcnt lgkmcnt(0)
    v_mfma_f32_16x16x32_bf16 v[24:27], v[128:131], v[160:163], v[24:27]
    ds_read2_b32 v[64:65], v8 offset0:128 offset1:129
    v_mfma_f32_16x16x32_bf16 v[28:31], v[128:131], v[164:167], v[28:31]
    ds_read2_b32 v[66:67], v8 offset0:130 offset1:131
    v_mfma_f32_16x16x32_bf16 v[32:35], v[128:131], v[168:171], v[32:35]
    ds_read_b128 v[96:99], v12 offset:0
    v_mfma_f32_16x16x32_bf16 v[36:39], v[128:131], v[172:175], v[36:39]
    ds_read2_b32 v[68:69], v8 offset0:0 offset1:1
    v_mfma_f32_16x16x32_bf16 v[40:43], v[128:131], v[176:179], v[40:43]
    ds_read2_b32 v[70:71], v8 offset0:2 offset1:3
    v_mfma_f32_16x16x32_bf16 v[44:47], v[128:131], v[180:183], v[44:47]
    ds_read_b128 v[100:103], v12 offset:512
    v_mfma_f32_16x16x32_bf16 v[48:51], v[128:131], v[184:187], v[48:51]
    ds_read2_b32 v[72:73], v9 offset0:128 offset1:129
    v_mfma_f32_16x16x32_bf16 v[52:55], v[128:131], v[188:191], v[52:55]
    ds_read2_b32 v[74:75], v9 offset0:130 offset1:131
    v_mfma_f32_16x16x32_bf16 v[28:31], v[132:135], v[160:163], v[28:31]
    ds_read_b128 v[104:107], v12 offset:1024
    v_mfma_f32_16x16x32_bf16 v[32:35], v[132:135], v[164:167], v[32:35]
    ds_read2_b32 v[76:77], v9 offset0:0 offset1:1
    v_mfma_f32_16x16x32_bf16 v[36:39], v[132:135], v[168:171], v[36:39]
    ds_read2_b32 v[78:79], v9 offset0:2 offset1:3
    v_mfma_f32_16x16x32_bf16 v[40:43], v[132:135], v[172:175], v[40:43]
    ds_read_b128 v[108:111], v12 offset:1536
    v_mfma_f32_16x16x32_bf16 v[44:47], v[132:135], v[176:179], v[44:47]
    ds_read2_b32 v[80:81], v10 offset0:128 offset1:129
    v_mfma_f32_16x16x32_bf16 v[48:51], v[132:135], v[180:183], v[48:51]
    ds_read2_b32 v[82:83], v10 offset0:130 offset1:131
    v_mfma_f32_16x16x32_bf16 v[52:55], v[132:135], v[184:187], v[52:55]
    ds_read_b128 v[112:115], v12 offset:2048
    v_mfma_f32_16x16x32_bf16 v[32:35], v[136:139], v[160:163], v[32:35]
    ds_read2_b32 v[84:85], v10 offset0:0 offset1:1
    v_mfma_f32_16x16x32_bf16 v[36:39], v[136:139], v[164:167], v[36:39]
    ds_read2_b32 v[86:87], v10 offset0:2 offset1:3
    v_mfma_f32_16x16x32_bf16 v[40:43], v[136:139], v[168:171], v[40:43]
    ds_read_b128 v[116:119], v12 offset:2560
    v_mfma_f32_16x16x32_bf16 v[44:47], v[136:139], v[172:175], v[44:47]
    ds_read2_b32 v[88:89], v11 offset0:128 offset1:129
    v_mfma_f32_16x16x32_bf16 v[48:51], v[136:139], v[176:179], v[48:51]
    ds_read2_b32 v[90:91], v11 offset0:130 offset1:131
    v_mfma_f32_16x16x32_bf16 v[52:55], v[136:139], v[180:183], v[52:55]
    ds_read_b128 v[120:123], v12 offset:3072
    v_mfma_f32_16x16x32_bf16 v[36:39], v[140:143], v[160:163], v[36:39]
    ds_read2_b32 v[92:93], v11 offset0:0 offset1:1
    v_mfma_f32_16x16x32_bf16 v[40:43], v[140:143], v[164:167], v[40:43]
    ds_read2_b32 v[94:95], v11 offset0:2 offset1:3
    v_mfma_f32_16x16x32_bf16 v[44:47], v[140:143], v[168:171], v[44:47]
    ds_read_b128 v[124:127], v12 offset:3584
    v_mfma_f32_16x16x32_bf16 v[48:51], v[140:143], v[172:175], v[48:51]
    v_subrev_u32 v8, 64, v8
    v_mfma_f32_16x16x32_bf16 v[52:55], v[140:143], v[176:179], v[52:55]
    v_subrev_u32 v9, 64, v9
    v_mfma_f32_16x16x32_bf16 v[40:43], v[144:147], v[160:163], v[40:43]
    v_subrev_u32 v10, 64, v10
    v_mfma_f32_16x16x32_bf16 v[44:47], v[144:147], v[164:167], v[44:47]
    v_subrev_u32 v11, 64, v11
    v_mfma_f32_16x16x32_bf16 v[48:51], v[144:147], v[168:171], v[48:51]
    v_subrev_u32 v12, 64, v12
    v_mfma_f32_16x16x32_bf16 v[52:55], v[144:147], v[172:175], v[52:55]
    v_mfma_f32_16x16x32_bf16 v[44:47], v[148:151], v[160:163], v[44:47]
    v_mfma_f32_16x16x32_bf16 v[48:51], v[148:151], v[164:167], v[48:51]
    v_mfma_f32_16x16x32_bf16 v[52:55], v[148:151], v[168:171], v[52:55]
    v_mfma_f32_16x16x32_bf16 v[48:51], v[152:155], v[160:163], v[48:51]
    v_mfma_f32_16x16x32_bf16 v[52:55], v[152:155], v[164:167], v[52:55]
    v_mfma_f32_16x16x32_bf16 v[52:55], v[156:159], v[160:163], v[52:55]
    s_sub_u32 s28, s28, 1
    s_cmp_lg_u32 s28, 0
    s_cbranch_scc1 L_cv_loop
    s_nop 7
    s_cmp_eq_u32 s33, 0
    s_cbranch_scc1 L_cv_t0
    v_cvt_pk_bf16_f32 v200, v24, v25
    v_cvt_pk_bf16_f32 v201, v26, v27
    v_cvt_pk_bf16_f32 v202, v28, v29
    v_cvt_pk_bf16_f32 v203, v30, v31
    v_cvt_pk_bf16_f32 v204, v32, v33
    v_cvt_pk_bf16_f32 v205, v34, v35
    v_cvt_pk_bf16_f32 v206, v36, v37
    v_cvt_pk_bf16_f32 v207, v38, v39
    ds_write_b128 v13, v[200:203]
    ds_write_b128 v13, v[204:207] offset:1024
    ds_write_b32 v15, v19
    v_mov_b32 v24, v40
    v_mov_b32 v25, v41
    v_mov_b32 v26, v42
    v_mov_b32 v27, v43
    v_mov_b32 v28, v44
    v_mov_b32 v29, v45
    v_mov_b32 v30, v46
    v_mov_b32 v31, v47
    v_mov_b32 v32, v48
    v_mov_b32 v33, v49
    v_mov_b32 v34, v50
    v_mov_b32 v35, v51
    v_mov_b32 v36, v52
    v_mov_b32 v37, v53
    v_mov_b32 v38, v54
    v_mov_b32 v39, v55
    s_branch L_cv_t1
L_cv_t0:
    v_cvt_pk_bf16_f32 v200, v40, v41
    v_cvt_pk_bf16_f32 v201, v42, v43
    v_cvt_pk_bf16_f32 v202, v44, v45
    v_cvt_pk_bf16_f32 v203, v46, v47
    v_cvt_pk_bf16_f32 v204, v48, v49
    v_cvt_pk_bf16_f32 v205, v50, v51
    v_cvt_pk_bf16_f32 v206, v52, v53
    v_cvt_pk_bf16_f32 v207, v54, v55
    ds_write_b128 v13, v[200:203]
    ds_write_b128 v13, v[204:207] offset:1024
    ds_write_b32 v15, v19
L_cv_t1:
    v_mov_b32 v16, s25
L_lw_cvx:
    s_sub_u32 s0, s0, 1
    s_cbranch_scc1 L_end
    ds_read_b32 v18, v16
    s_waitcnt lgkmcnt(0)
    v_cmp_gt_u32 vcc, 1, v18
    s_cbranch_vccnz L_lw_cvx
    ds_read_b128 v[208:211], v14
    ds_read_b128 v[212:215], v14 offset:1024
    s_waitcnt lgkmcnt(0)
    v_lshlrev_b32 v216, 16, v208
    v_and_b32 v217, s31, v208
    v_add_f32 v24, v24, v216
    v_add_f32 v25, v25, v217
    v_lshlrev_b32 v216, 16, v209
    v_and_b32 v217, s31, v209
    v_add_f32 v26, v26, v216
    v_add_f32 v27, v27, v217
    v_lshlrev_b32 v216, 16, v210
    v_and_b32 v217, s31, v210
    v_add_f32 v28, v28, v216
    v_add_f32 v29, v29, v217
    v_lshlrev_b32 v216, 16, v211
    v_and_b32 v217, s31, v211
    v_add_f32 v30, v30, v216
    v_add_f32 v31, v31, v217
    v_cvt_pk_bf16_f32 v96, v24, v25
    v_cvt_pk_bf16_f32 v97, v26, v27
    v_cvt_pk_bf16_f32 v98, v28, v29
    v_cvt_pk_bf16_f32 v99, v30, v31
    s_nop 1
    v_permlane16_swap_b32 v96, v98
    v_permlane16_swap_b32 v97, v99
    buffer_store_dwordx4 v[96:99], v6, s[20:23], s26 offen offset:0 sc1
    v_lshlrev_b32 v216, 16, v212
    v_and_b32 v217, s31, v212
    v_add_f32 v32, v32, v216
    v_add_f32 v33, v33, v217
    v_lshlrev_b32 v216, 16, v213
    v_and_b32 v217, s31, v213
    v_add_f32 v34, v34, v216
    v_add_f32 v35, v35, v217
    v_lshlrev_b32 v216, 16, v214
    v_and_b32 v217, s31, v214
    v_add_f32 v36, v36, v216
    v_add_f32 v37, v37, v217
    v_lshlrev_b32 v216, 16, v215
    v_and_b32 v217, s31, v215
    v_add_f32 v38, v38, v216
    v_add_f32 v39, v39, v217
    v_cvt_pk_bf16_f32 v100, v32, v33
    v_cvt_pk_bf16_f32 v101, v34, v35
    v_cvt_pk_bf16_f32 v102, v36, v37
    v_cvt_pk_bf16_f32 v103, v38, v39
    s_nop 1
    v_permlane16_swap_b32 v100, v102
    v_permlane16_swap_b32 v101, v103
    buffer_store_dwordx4 v[100:103], v6, s[20:23], s26 offen offset:1024 sc1
    s_waitcnt vmcnt(0)
    v_mov_b32 v4, 1
    v_mov_b32 v3, 0
    s_mov_b64 exec, 1
    buffer_store_dword v4, v3, s[20:23], s27 offen sc1
    s_mov_b64 exec, -1
L_end:
L_codeend:
    s_endpgm
.section .rodata,"a"
.p2align 6
.amdhsa_kernel gated_mix__ssm_conv_s4__glu_gated_swiglu__prompt_kernel
  .amdhsa_next_free_vgpr 256
  .amdhsa_next_free_sgpr 102
  .amdhsa_accum_offset 256
  .amdhsa_group_segment_fixed_size 0
  .amdhsa_kernarg_size 136
  .amdhsa_user_sgpr_count 2
  .amdhsa_user_sgpr_kernarg_segment_ptr 1
  .amdhsa_system_sgpr_workgroup_id_x 1
.end_amdhsa_kernel
```
